```python
import torch

def _softmax(x, axis=-1):
    return torch.softmax(x, dim=axis)
def _gelu(x):
    return torch.nn.functional.gelu(x, approximate="tanh")
def _silu(x):
    return torch.nn.functional.silu(x)
def _sigmoid(x):
    return torch.sigmoid(x)
def _layernorm(x, axis=-1, eps=1e-5):
    m = x.mean(dim=axis, keepdim=True)
    v = x.var(dim=axis, keepdim=True, unbiased=False)
    return (x - m) / torch.sqrt(v + eps)
def _scatter_add(tgt, idx, src, axis=0):
    return tgt.clone().index_add_(axis, idx, src)
def _segment_sum(src, seg, n):
    out = torch.zeros((n,) + src.shape[1:], dtype=src.dtype)
    return out.index_add_(0, seg, src)
def _pad(x, pw):
    flat = tuple(v for pair in reversed(pw) for v in pair)
    return torch.nn.functional.pad(x, flat)

kernel_name = 'parallel_sum__mha_block_cached__dense_activation_relu__decode'

def setup_inputs():

    _w = (lambda a: (lambda t: t.to(torch.bfloat16) if t.is_floating_point() else t)(torch.as_tensor(a)))
    def _A_setup():
        B, Sq, D = 2, 1, 640
        H, Sk, Dh = 32, 8192, 192
        return {
            "x": _w((lambda *s: torch.randn(*s, dtype=torch.bfloat16) * 0.05)(B, Sq, D)),
            "k_cache": _w((lambda *s: torch.randn(*s, dtype=torch.bfloat16) * 3.2)(B, H, Sk, Dh)),
            "v_cache": _w((lambda *s: torch.randn(*s, dtype=torch.bfloat16) * 1.6)(B, H, Sk, Dh)),
            "wq": _w((lambda *s: torch.randn(*s, dtype=torch.bfloat16) * 3.2)(D, H * Dh) * (D ** -0.5)),
            "wo": _w((lambda *s: torch.randn(*s, dtype=torch.bfloat16) * 1.6)(H * Dh, D) * ((H * Dh) ** -0.5)),
        }
    _A_in = _A_setup()

    def _B_setup():
        B, S, D, Dff = 2, 1, 640, 1536
        return {
            "x": _w((lambda *s: torch.randn(*s, dtype=torch.bfloat16) * 0.05)(B, S, D)),
            "w1": _w((lambda *s: torch.randn(*s, dtype=torch.bfloat16) * 0.05)(D, Dff)),
            "w2": _w((lambda *s: torch.randn(*s, dtype=torch.bfloat16) * 0.05)(Dff, D)),
        }
    _B_in = _B_setup()

    return {
        "A_x": _A_in["x"],
        "A_k_cache": _A_in["k_cache"],
        "A_v_cache": _A_in["v_cache"],
        "A_wq": _A_in["wq"],
        "A_wo": _A_in["wo"],
        "B_x": _B_in["x"],
        "B_w1": _B_in["w1"],
        "B_w2": _B_in["w2"],
    }

def reference(A_x, A_k_cache, A_v_cache, A_wq, A_wo, B_x, B_w1, B_w2):
    def _A_ref(x, k_cache, v_cache, wq, wo):
        B, Sq, D = x.shape
        H, Dh = 32, 192
        q = (lambda x, *d: x.permute(*d))((x @ wq).reshape(B, Sq, H, Dh), 0, 2, 1, 3)
        scores = torch.einsum("bhqd,bhkd->bhqk", q, k_cache) * (Dh ** -0.5)
        p = _softmax(scores, axis=-1)
        o = torch.einsum("bhqk,bhkd->bhqd", p, v_cache)
        return (lambda x, *d: x.permute(*d))(o, 0, 2, 1, 3).reshape(B, Sq, H * Dh) @ wo

    def _B_ref(x, w1, w2):
        h = torch.einsum("bsd,df->bsf", x, w1)
        zero = torch.zeros_like(h)
        h = torch.maximum(h, zero)
        return torch.einsum("bsf,fd->bsd", h, w2)

    x = A_x
    xn = _layernorm(x, axis=-1)
    return x + _A_ref(xn, A_k_cache, A_v_cache, A_wq, A_wo) + _B_ref(xn, B_w1, B_w2)
```

```asm
; @launch grid=(256,1,1) block=(384,1,1) lds=97280
.amdgcn_target "amdgcn-amd-amdhsa--gfx950"
.text
.globl parallel_sum__mha_block_cached__dense_activation_relu__decode_kernel
.p2align 8
.type parallel_sum__mha_block_cached__dense_activation_relu__decode_kernel,@function
parallel_sum__mha_block_cached__dense_activation_relu__decode_kernel:
    s_load_dwordx2 s[8:9], s[0:1], 8
    v_readfirstlane_b32 s3, v0
    s_lshr_b32 s42, s2, 8
    s_cbranch_scc1 L_end
    s_and_b32 s42, s2, 7
    s_lshr_b32 s36, s2, 6
    s_lshl3_add_u32 s36, s36, s42
    s_lshr_b32 s37, s2, 3
    s_and_b32 s37, s37, 7
    s_lshr_b32 s3, s3, 6
    s_cbranch_scc0 L_helper
    s_cmp_eq_u32 s3, 5
    s_cbranch_scc1 L_ctl
    s_mov_b32 s10, 201326592
    s_mov_b32 s11, 0x20000
    v_bfe_u32 v43, v0, 3, 3
    v_and_b32 v3, 7, v0
    v_lshlrev_b32 v3, 4, v3
    s_movk_i32 s43, 384
    v_mad_u32_u24 v2, v43, s43, v3
    s_lshl_b32 s38, s36, 8
    s_add_u32 s38, s38, s37
    s_lshl2_add_u32 s38, s38, s3
    s_sub_u32 s38, s38, 1
    s_mulk_i32 s38, 3072
    s_lshl_b32 s41, s43, 8
    s_mov_b32 s39, s38
    s_waitcnt lgkmcnt(0)
    buffer_load_dwordx4 v[64:67], v2, s[8:11], s38 offen offset:0 nt
    buffer_load_dwordx4 v[68:71], v2, s[8:11], s38 offen offset:128 nt
    buffer_load_dwordx4 v[72:75], v2, s[8:11], s38 offen offset:256 nt
    s_add_u32 s38, s38, s41
    buffer_load_dwordx4 v[76:79], v2, s[8:11], s38 offen offset:0 nt
    buffer_load_dwordx4 v[80:83], v2, s[8:11], s38 offen offset:128 nt
    buffer_load_dwordx4 v[84:87], v2, s[8:11], s38 offen offset:256 nt
    s_add_u32 s38, s38, s41
    s_load_dwordx2 s[12:13], s[0:1], 16
    s_load_dwordx2 s[24:25], s[0:1], 80
    s_mov_b32 s26, 4194304
    s_mov_b32 s27, 0x20000
    s_cmp_eq_u32 s3, 4
    s_cselect_b32 s42, 56, 32
    s_load_dwordx2 s[16:17], s[0:1], s42
    v_and_b32 v1, 63, v0
    s_mov_b32 s40, 0
    s_mov_b32 s45, -1
    s_lshl_b32 s42, s3, 2
    s_add_u32 s42, s42, 5564
    v_mov_b32 v57, s42
    v_mov_b32 v41, 5504
    v_mov_b32 v44, 0
    v_mov_b32 v45, 0x1000
    ds_write_b32 v57, v44
    ds_write_b64 v41, v[44:45] offset:80
    s_waitcnt lgkmcnt(0)
    s_barrier
    s_mul_i32 s47, s36, 3
    s_add_u32 s47, s47, s3
    s_sub_u32 s47, s47, 1
    s_cmp_lt_u32 s36, 24
    s_cselect_b32 s48, 1966080, 0
    s_cmp_eq_u32 s3, 4
    s_cselect_b32 s47, s36, s47
    s_cselect_b32 s18, s48, 7864320
    s_mov_b32 s19, 0x20000
    s_mul_i32 s47, s47, 81920
    s_mul_i32 s48, s37, 160
    s_add_u32 s51, s47, s48
    s_mul_i32 s49, s3, 10240
    s_add_u32 s49, s49, 46080
    v_add_u32 v13, 0, v1
    v_mul_u32_u24 v14, 6554, v13
    v_lshrrev_b32 v14, 16, v14
    v_mul_u32_u24 v15, 10, v14
    v_sub_u32 v15, v13, v15
    v_mul_u32_u24 v14, 1280, v14
    v_lshl_add_u32 v8, v15, 4, v14
    v_add_u32 v13, 64, v1
    v_mul_u32_u24 v14, 6554, v13
    v_lshrrev_b32 v14, 16, v14
    v_mul_u32_u24 v15, 10, v14
    v_sub_u32 v15, v13, v15
    v_mul_u32_u24 v14, 1280, v14
    v_lshl_add_u32 v9, v15, 4, v14
    v_add_u32 v13, 128, v1
    v_mul_u32_u24 v14, 6554, v13
    v_lshrrev_b32 v14, 16, v14
    v_mul_u32_u24 v15, 10, v14
    v_sub_u32 v15, v13, v15
    v_mul_u32_u24 v14, 1280, v14
    v_lshl_add_u32 v10, v15, 4, v14
    v_add_u32 v13, 192, v1
    v_mul_u32_u24 v14, 6554, v13
    v_lshrrev_b32 v14, 16, v14
    v_mul_u32_u24 v15, 10, v14
    v_sub_u32 v15, v13, v15
    v_mul_u32_u24 v14, 1280, v14
    v_lshl_add_u32 v11, v15, 4, v14
    v_add_u32 v13, 256, v1
    v_mul_u32_u24 v14, 6554, v13
    v_lshrrev_b32 v14, 16, v14
    v_mul_u32_u24 v15, 10, v14
    v_sub_u32 v15, v13, v15
    v_mul_u32_u24 v14, 1280, v14
    v_lshl_add_u32 v12, v15, 4, v14
    s_waitcnt vmcnt(3)
    s_add_u32 m0, s49, 0
    s_nop 0
    buffer_load_dwordx4 v8, s[16:19], s51 offen lds
    s_add_u32 m0, s49, 1024
    s_nop 0
    buffer_load_dwordx4 v9, s[16:19], s51 offen lds
    s_add_u32 m0, s49, 2048
    s_nop 0
    buffer_load_dwordx4 v10, s[16:19], s51 offen lds
    s_waitcnt vmcnt(3)
    s_add_u32 m0, s49, 3072
    s_nop 0
    buffer_load_dwordx4 v11, s[16:19], s51 offen lds
    s_add_u32 m0, s49, 4096
    s_nop 0
    buffer_load_dwordx4 v12, s[16:19], s51 offen lds
    s_and_b32 s47, s36, 24
    s_add_u32 s47, s47, s37
    s_and_b32 s48, s36, 7
    s_add_u32 s48, s48, 32
    s_lshl_b32 s48, s48, 8
    s_add_u32 s48, s48, s47
    s_lshl2_add_u32 s48, s48, s3
    s_sub_u32 s48, s48, 1
    s_mul_i32 s50, s48, 3072
    v_and_b32 v43, 1, v1
    v_cmp_eq_u32 vcc, 1, v43
    v_mov_b32 v16, 0xffff
    v_mov_b32 v17, 0xffff0000
    v_cndmask_b32 v16, v16, v17, vcc
    v_bfe_u32 v43, v1, 1, 2
    v_cmp_eq_u32 vcc, 0, v43
    s_nop 1
    v_cndmask_b32 v4, 0, v16, vcc
    v_cmp_eq_u32 vcc, 1, v43
    s_nop 1
    v_cndmask_b32 v5, 0, v16, vcc
    v_cmp_eq_u32 vcc, 2, v43
    s_nop 1
    v_cndmask_b32 v6, 0, v16, vcc
    v_cmp_eq_u32 vcc, 3, v43
    s_nop 1
    v_cndmask_b32 v7, 0, v16, vcc
    v_lshrrev_b32 v43, 5, v1
    v_mul_u32_u24 v42, 768, v43
    v_lshl_add_u32 v42, v3, 1, v42
    v_and_b32 v43, 16, v1
    s_mul_i32 s42, s3, 1536
    s_add_u32 s42, s42, 13824
    v_add3_u32 v42, v42, v43, s42
    s_lshl_b32 s42, s3, 3
    s_add_u32 s42, s42, 5624
    v_and_b32 v43, 0x60, v3
    v_add_u32 v46, s42, v43
    v_mov_b32 v47, 1
    v_mov_b32 v56, 5504
    v_lshrrev_b32 v43, 3, v1
    v_mul_u32_u24 v60, 272, v43
    s_mul_i32 s42, s3, 2304
    s_add_u32 s42, s42, 3584
    v_add_u32 v60, s42, v60
    v_add_u32 v61, v60, v3
    s_waitcnt vmcnt(3)
    buffer_load_dwordx4 v[88:91], v2, s[8:11], s38 offen offset:0 nt
    buffer_load_dwordx4 v[92:95], v2, s[8:11], s38 offen offset:128 nt
    buffer_load_dwordx4 v[96:99], v2, s[8:11], s38 offen offset:256 nt
    s_add_u32 s38, s38, s41
L_kloop:
    ds_read_b64 v[44:45], v41 offset:80
    s_add_u32 s45, s45, 1
    v_mov_b32 v58, s45
    s_lshl_b32 s53, s45, 2
    s_waitcnt vmcnt(6) lgkmcnt(0)
    v_readfirstlane_b32 s46, v44
    v_readfirstlane_b32 s52, v45
    s_cmp_lt_i32 s53, s46
    s_cbranch_scc1 L_wk0
    s_waitcnt vmcnt(3)
    s_cmp_le_i32 s53, s52
    s_cbranch_scc1 L_wk0
    s_waitcnt vmcnt(0)
L_wk0:
    buffer_load_dwordx4 v[100:103], v2, s[8:11], s38 offen offset:0 nt
    buffer_load_dwordx4 v[104:107], v2, s[8:11], s38 offen offset:128 nt
    buffer_load_dwordx4 v[108:111], v2, s[8:11], s38 offen offset:256 nt
    s_add_u32 s38, s38, s41
    ds_write_b32 v57, v58
    ds_read_b64 v[44:45], v41 offset:80
    s_add_u32 s45, s45, 1
    v_mov_b32 v58, s45
    s_lshl_b32 s53, s45, 2
    s_waitcnt vmcnt(6) lgkmcnt(0)
    v_readfirstlane_b32 s46, v44
    v_readfirstlane_b32 s52, v45
    s_cmp_lt_i32 s53, s46
    s_cbranch_scc1 L_wk1
    s_waitcnt vmcnt(3)
    s_cmp_le_i32 s53, s52
    s_cbranch_scc1 L_wk1
    s_waitcnt vmcnt(0)
L_wk1:
    buffer_load_dwordx4 v[112:115], v2, s[8:11], s38 offen offset:0 nt
    buffer_load_dwordx4 v[116:119], v2, s[8:11], s38 offen offset:128 nt
    buffer_load_dwordx4 v[120:123], v2, s[8:11], s38 offen offset:256 nt
    s_add_u32 s38, s38, s41
    ds_write_b32 v57, v58
    ds_read_b64 v[44:45], v41 offset:80
    s_add_u32 s45, s45, 1
    v_mov_b32 v58, s45
    s_lshl_b32 s53, s45, 2
    s_waitcnt vmcnt(6) lgkmcnt(0)
    v_readfirstlane_b32 s46, v44
    v_readfirstlane_b32 s52, v45
    s_cmp_lt_i32 s53, s46
    s_cbranch_scc1 L_wk2
    s_waitcnt vmcnt(3)
    s_cmp_le_i32 s53, s52
    s_cbranch_scc1 L_wk2
    s_waitcnt vmcnt(0)
L_wk2:
    buffer_load_dwordx4 v[124:127], v2, s[8:11], s38 offen offset:0 nt
    buffer_load_dwordx4 v[128:131], v2, s[8:11], s38 offen offset:128 nt
    buffer_load_dwordx4 v[132:135], v2, s[8:11], s38 offen offset:256 nt
    s_add_u32 s38, s38, s41
    ds_write_b32 v57, v58
    ds_read_b64 v[44:45], v41 offset:80
    s_add_u32 s45, s45, 1
    v_mov_b32 v58, s45
    s_lshl_b32 s53, s45, 2
    s_waitcnt vmcnt(6) lgkmcnt(0)
    v_readfirstlane_b32 s46, v44
    v_readfirstlane_b32 s52, v45
    s_cmp_lt_i32 s53, s46
    s_cbranch_scc1 L_wk3
    s_waitcnt vmcnt(3)
    s_cmp_le_i32 s53, s52
    s_cbranch_scc1 L_wk3
    s_waitcnt vmcnt(0)
L_wk3:
    buffer_load_dwordx4 v[136:139], v2, s[8:11], s38 offen offset:0 nt
    buffer_load_dwordx4 v[140:143], v2, s[8:11], s38 offen offset:128 nt
    buffer_load_dwordx4 v[144:147], v2, s[8:11], s38 offen offset:256 nt
    s_add_u32 s38, s38, s41
    ds_write_b32 v57, v58
    ds_read_b64 v[44:45], v41 offset:80
    s_add_u32 s45, s45, 1
    v_mov_b32 v58, s45
    s_lshl_b32 s53, s45, 2
    s_waitcnt vmcnt(6) lgkmcnt(0)
    v_readfirstlane_b32 s46, v44
    v_readfirstlane_b32 s52, v45
    s_cmp_lt_i32 s53, s46
    s_cbranch_scc1 L_wk4
    s_waitcnt vmcnt(3)
    s_cmp_le_i32 s53, s52
    s_cbranch_scc1 L_wk4
    s_waitcnt vmcnt(0)
L_wk4:
    buffer_load_dwordx4 v[148:151], v2, s[8:11], s38 offen offset:0 nt
    buffer_load_dwordx4 v[152:155], v2, s[8:11], s38 offen offset:128 nt
    buffer_load_dwordx4 v[156:159], v2, s[8:11], s38 offen offset:256 nt
    s_add_u32 s38, s38, s41
    ds_write_b32 v57, v58
    ds_read_b64 v[44:45], v41 offset:80
    s_add_u32 s45, s45, 1
    v_mov_b32 v58, s45
    s_lshl_b32 s53, s45, 2
    s_waitcnt vmcnt(6) lgkmcnt(0)
    v_readfirstlane_b32 s46, v44
    v_readfirstlane_b32 s52, v45
    s_cmp_lt_i32 s53, s46
    s_cbranch_scc1 L_wk5
    s_waitcnt vmcnt(3)
    s_cmp_le_i32 s53, s52
    s_cbranch_scc1 L_wk5
    s_waitcnt vmcnt(0)
L_wk5:
    s_cmp_ge_u32 s40, 2
    s_cselect_b32 s42, 22020096, 0
    s_add_u32 s38, s38, s42
    buffer_load_dwordx4 v[160:163], v2, s[8:11], s38 offen offset:0 nt
    buffer_load_dwordx4 v[164:167], v2, s[8:11], s38 offen offset:128 nt
    buffer_load_dwordx4 v[168:171], v2, s[8:11], s38 offen offset:256 nt
    s_add_u32 s38, s38, s41
    ds_write_b32 v57, v58
    ds_read_b64 v[44:45], v41 offset:80
    s_add_u32 s45, s45, 1
    v_mov_b32 v58, s45
    s_lshl_b32 s53, s45, 2
    s_waitcnt vmcnt(6) lgkmcnt(0)
    v_readfirstlane_b32 s46, v44
    v_readfirstlane_b32 s52, v45
    s_cmp_lt_i32 s53, s46
    s_cbranch_scc1 L_wk6
    s_waitcnt vmcnt(3)
    s_cmp_le_i32 s53, s52
    s_cbranch_scc1 L_wk6
    s_waitcnt vmcnt(0)
L_wk6:
    buffer_load_dwordx4 v[172:175], v2, s[8:11], s38 offen offset:0 nt
    buffer_load_dwordx4 v[176:179], v2, s[8:11], s38 offen offset:128 nt
    buffer_load_dwordx4 v[180:183], v2, s[8:11], s38 offen offset:256 nt
    s_add_u32 s38, s38, s41
    ds_write_b32 v57, v58
    ds_read_b64 v[44:45], v41 offset:80
    s_add_u32 s45, s45, 1
    v_mov_b32 v58, s45
    s_lshl_b32 s53, s45, 2
    s_waitcnt vmcnt(6) lgkmcnt(0)
    v_readfirstlane_b32 s46, v44
    v_readfirstlane_b32 s52, v45
    s_cmp_lt_i32 s53, s46
    s_cbranch_scc1 L_wk7
    s_waitcnt vmcnt(3)
    s_cmp_le_i32 s53, s52
    s_cbranch_scc1 L_wk7
    s_waitcnt vmcnt(0)
L_wk7:
    buffer_load_dwordx4 v[184:187], v2, s[8:11], s38 offen offset:0 nt
    buffer_load_dwordx4 v[188:191], v2, s[8:11], s38 offen offset:128 nt
    buffer_load_dwordx4 v[192:195], v2, s[8:11], s38 offen offset:256 nt
    s_add_u32 s38, s38, s41
    ds_write_b32 v57, v58
    ds_read_b64 v[44:45], v41 offset:80
    s_add_u32 s45, s45, 1
    v_mov_b32 v58, s45
    s_lshl_b32 s53, s45, 2
    s_waitcnt vmcnt(6) lgkmcnt(0)
    v_readfirstlane_b32 s46, v44
    v_readfirstlane_b32 s52, v45
    s_cmp_lt_i32 s53, s46
    s_cbranch_scc1 L_wk8
    s_waitcnt vmcnt(3)
    s_cmp_le_i32 s53, s52
    s_cbranch_scc1 L_wk8
    s_waitcnt vmcnt(0)
L_wk8:
    buffer_load_dwordx4 v[196:199], v2, s[8:11], s38 offen offset:0 nt
    buffer_load_dwordx4 v[200:203], v2, s[8:11], s38 offen offset:128 nt
    buffer_load_dwordx4 v[204:207], v2, s[8:11], s38 offen offset:256 nt
    s_add_u32 s38, s38, s41
    ds_write_b32 v57, v58
    ds_read_b64 v[44:45], v41 offset:80
    s_add_u32 s45, s45, 1
    v_mov_b32 v58, s45
    s_lshl_b32 s53, s45, 2
    s_waitcnt vmcnt(6) lgkmcnt(0)
    v_readfirstlane_b32 s46, v44
    v_readfirstlane_b32 s52, v45
    s_cmp_lt_i32 s53, s46
    s_cbranch_scc1 L_wk9
    s_waitcnt vmcnt(3)
    s_cmp_le_i32 s53, s52
    s_cbranch_scc1 L_wk9
    s_waitcnt vmcnt(0)
L_wk9:
    buffer_load_dwordx4 v[208:211], v2, s[8:11], s38 offen offset:0 nt
    buffer_load_dwordx4 v[212:215], v2, s[8:11], s38 offen offset:128 nt
    buffer_load_dwordx4 v[216:219], v2, s[8:11], s38 offen offset:256 nt
    s_add_u32 s38, s38, s41
    ds_write_b32 v57, v58
    ds_read_b64 v[44:45], v41 offset:80
    s_add_u32 s45, s45, 1
    v_mov_b32 v58, s45
    s_lshl_b32 s53, s45, 2
    s_waitcnt vmcnt(6) lgkmcnt(0)
    v_readfirstlane_b32 s46, v44
    v_readfirstlane_b32 s52, v45
    s_cmp_lt_i32 s53, s46
    s_cbranch_scc1 L_wk10
    s_waitcnt vmcnt(3)
    s_cmp_le_i32 s53, s52
    s_cbranch_scc1 L_wk10
    s_waitcnt vmcnt(0)
L_wk10:
    buffer_load_dwordx4 v[220:223], v2, s[8:11], s38 offen offset:0 nt
    buffer_load_dwordx4 v[224:227], v2, s[8:11], s38 offen offset:128 nt
    buffer_load_dwordx4 v[228:231], v2, s[8:11], s38 offen offset:256 nt
    s_add_u32 s38, s38, s41
    ds_write_b32 v57, v58
    s_lshr_b32 s43, s40, 1
L_wq:
    ds_read_b32 v43, v41 offset:24
    s_waitcnt lgkmcnt(0)
    v_readfirstlane_b32 s42, v43
    s_cmp_le_u32 s42, s43
    s_cbranch_scc1 L_wq
    s_lshl_b32 s42, s40, 1
    s_add_i32 s42, s42, -3
    s_max_i32 s42, s42, 0
    s_mulk_i32 s42, 384
    v_add_u32 v40, s42, v3
    ds_read_b128 v[8:11], v40 offset:2560
    ds_read_b128 v[12:15], v40 offset:2688
    ds_read_b128 v[16:19], v40 offset:2816
    s_waitcnt lgkmcnt(0)
    v_mov_b32 v20, 0
    v_mov_b32 v21, 0
    v_mov_b32 v22, 0
    v_mov_b32 v23, 0
    v_dot2c_f32_bf16 v20, v64, v8
    v_dot2c_f32_bf16 v21, v76, v8
    v_dot2c_f32_bf16 v22, v88, v8
    v_dot2c_f32_bf16 v23, v100, v8
    v_dot2c_f32_bf16 v20, v65, v9
    v_dot2c_f32_bf16 v21, v77, v9
    v_dot2c_f32_bf16 v22, v89, v9
    v_dot2c_f32_bf16 v23, v101, v9
    v_dot2c_f32_bf16 v20, v66, v10
    v_dot2c_f32_bf16 v21, v78, v10
    v_dot2c_f32_bf16 v22, v90, v10
    v_dot2c_f32_bf16 v23, v102, v10
    v_dot2c_f32_bf16 v20, v67, v11
    v_dot2c_f32_bf16 v21, v79, v11
    v_dot2c_f32_bf16 v22, v91, v11
    v_dot2c_f32_bf16 v23, v103, v11
    v_dot2c_f32_bf16 v20, v68, v12
    v_dot2c_f32_bf16 v21, v80, v12
    v_dot2c_f32_bf16 v22, v92, v12
    v_dot2c_f32_bf16 v23, v104, v12
    v_dot2c_f32_bf16 v20, v69, v13
    v_dot2c_f32_bf16 v21, v81, v13
    v_dot2c_f32_bf16 v22, v93, v13
    v_dot2c_f32_bf16 v23, v105, v13
    v_dot2c_f32_bf16 v20, v70, v14
    v_dot2c_f32_bf16 v21, v82, v14
    v_dot2c_f32_bf16 v22, v94, v14
    v_dot2c_f32_bf16 v23, v106, v14
    v_dot2c_f32_bf16 v20, v71, v15
    v_dot2c_f32_bf16 v21, v83, v15
    v_dot2c_f32_bf16 v22, v95, v15
    v_dot2c_f32_bf16 v23, v107, v15
    v_dot2c_f32_bf16 v20, v72, v16
    v_dot2c_f32_bf16 v21, v84, v16
    v_dot2c_f32_bf16 v22, v96, v16
    v_dot2c_f32_bf16 v23, v108, v16
    v_dot2c_f32_bf16 v20, v73, v17
    v_dot2c_f32_bf16 v21, v85, v17
    v_dot2c_f32_bf16 v22, v97, v17
    v_dot2c_f32_bf16 v23, v109, v17
    v_dot2c_f32_bf16 v20, v74, v18
    v_dot2c_f32_bf16 v21, v86, v18
    v_dot2c_f32_bf16 v22, v98, v18
    v_dot2c_f32_bf16 v23, v110, v18
    v_dot2c_f32_bf16 v20, v75, v19
    v_dot2c_f32_bf16 v21, v87, v19
    v_dot2c_f32_bf16 v22, v99, v19
    v_dot2c_f32_bf16 v23, v111, v19
    v_add_f32_dpp v20, v20, v20 quad_perm:[1,0,3,2] row_mask:0xf bank_mask:0xf
    v_add_f32_dpp v21, v21, v21 quad_perm:[1,0,3,2] row_mask:0xf bank_mask:0xf
    v_add_f32_dpp v22, v22, v22 quad_perm:[1,0,3,2] row_mask:0xf bank_mask:0xf
    v_add_f32_dpp v23, v23, v23 quad_perm:[1,0,3,2] row_mask:0xf bank_mask:0xf
    v_add_f32_dpp v20, v20, v20 quad_perm:[2,3,0,1] row_mask:0xf bank_mask:0xf
    v_add_f32_dpp v21, v21, v21 quad_perm:[2,3,0,1] row_mask:0xf bank_mask:0xf
    v_add_f32_dpp v22, v22, v22 quad_perm:[2,3,0,1] row_mask:0xf bank_mask:0xf
    v_add_f32_dpp v23, v23, v23 quad_perm:[2,3,0,1] row_mask:0xf bank_mask:0xf
    v_add_f32_dpp v20, v20, v20 row_half_mirror row_mask:0xf bank_mask:0xf
    v_add_f32_dpp v21, v21, v21 row_half_mirror row_mask:0xf bank_mask:0xf
    v_add_f32_dpp v22, v22, v22 row_half_mirror row_mask:0xf bank_mask:0xf
    v_add_f32_dpp v23, v23, v23 row_half_mirror row_mask:0xf bank_mask:0xf
    ds_write_b128 v60, v[20:23] offset:0
    ds_read_b64 v[44:45], v41 offset:80
    s_add_u32 s45, s45, 1
    v_mov_b32 v58, s45
    s_lshl_b32 s53, s45, 2
    s_waitcnt vmcnt(6) lgkmcnt(0)
    v_readfirstlane_b32 s46, v44
    v_readfirstlane_b32 s52, v45
    s_cmp_lt_i32 s53, s46
    s_cbranch_scc1 L_wk11
    s_waitcnt vmcnt(3)
    s_cmp_le_i32 s53, s52
    s_cbranch_scc1 L_wk11
    s_waitcnt vmcnt(0)
L_wk11:
    buffer_load_dwordx4 v[232:235], v2, s[8:11], s38 offen offset:0 nt
    buffer_load_dwordx4 v[236:239], v2, s[8:11], s38 offen offset:128 nt
    buffer_load_dwordx4 v[240:243], v2, s[8:11], s38 offen offset:256 nt
    s_add_u32 s38, s38, s41
    ds_write_b32 v57, v58
    v_mov_b32 v20, 0
    v_mov_b32 v21, 0
    v_mov_b32 v22, 0
    v_mov_b32 v23, 0
    v_dot2c_f32_bf16 v20, v112, v8
    v_dot2c_f32_bf16 v21, v124, v8
    v_dot2c_f32_bf16 v22, v136, v8
    v_dot2c_f32_bf16 v23, v148, v8
    v_dot2c_f32_bf16 v20, v113, v9
    v_dot2c_f32_bf16 v21, v125, v9
    v_dot2c_f32_bf16 v22, v137, v9
    v_dot2c_f32_bf16 v23, v149, v9
    v_dot2c_f32_bf16 v20, v114, v10
    v_dot2c_f32_bf16 v21, v126, v10
    v_dot2c_f32_bf16 v22, v138, v10
    v_dot2c_f32_bf16 v23, v150, v10
    v_dot2c_f32_bf16 v20, v115, v11
    v_dot2c_f32_bf16 v21, v127, v11
    v_dot2c_f32_bf16 v22, v139, v11
    v_dot2c_f32_bf16 v23, v151, v11
    v_dot2c_f32_bf16 v20, v116, v12
    v_dot2c_f32_bf16 v21, v128, v12
    v_dot2c_f32_bf16 v22, v140, v12
    v_dot2c_f32_bf16 v23, v152, v12
    v_dot2c_f32_bf16 v20, v117, v13
    v_dot2c_f32_bf16 v21, v129, v13
    v_dot2c_f32_bf16 v22, v141, v13
    v_dot2c_f32_bf16 v23, v153, v13
    v_dot2c_f32_bf16 v20, v118, v14
    v_dot2c_f32_bf16 v21, v130, v14
    v_dot2c_f32_bf16 v22, v142, v14
    v_dot2c_f32_bf16 v23, v154, v14
    v_dot2c_f32_bf16 v20, v119, v15
    v_dot2c_f32_bf16 v21, v131, v15
    v_dot2c_f32_bf16 v22, v143, v15
    v_dot2c_f32_bf16 v23, v155, v15
    v_dot2c_f32_bf16 v20, v120, v16
    v_dot2c_f32_bf16 v21, v132, v16
    v_dot2c_f32_bf16 v22, v144, v16
    v_dot2c_f32_bf16 v23, v156, v16
    v_dot2c_f32_bf16 v20, v121, v17
    v_dot2c_f32_bf16 v21, v133, v17
    v_dot2c_f32_bf16 v22, v145, v17
    v_dot2c_f32_bf16 v23, v157, v17
    v_dot2c_f32_bf16 v20, v122, v18
    v_dot2c_f32_bf16 v21, v134, v18
    v_dot2c_f32_bf16 v22, v146, v18
    v_dot2c_f32_bf16 v23, v158, v18
    v_dot2c_f32_bf16 v20, v123, v19
    v_dot2c_f32_bf16 v21, v135, v19
    v_dot2c_f32_bf16 v22, v147, v19
    v_dot2c_f32_bf16 v23, v159, v19
    v_add_f32_dpp v20, v20, v20 quad_perm:[1,0,3,2] row_mask:0xf bank_mask:0xf
    v_add_f32_dpp v21, v21, v21 quad_perm:[1,0,3,2] row_mask:0xf bank_mask:0xf
    v_add_f32_dpp v22, v22, v22 quad_perm:[1,0,3,2] row_mask:0xf bank_mask:0xf
    v_add_f32_dpp v23, v23, v23 quad_perm:[1,0,3,2] row_mask:0xf bank_mask:0xf
    v_add_f32_dpp v20, v20, v20 quad_perm:[2,3,0,1] row_mask:0xf bank_mask:0xf
    v_add_f32_dpp v21, v21, v21 quad_perm:[2,3,0,1] row_mask:0xf bank_mask:0xf
    v_add_f32_dpp v22, v22, v22 quad_perm:[2,3,0,1] row_mask:0xf bank_mask:0xf
    v_add_f32_dpp v23, v23, v23 quad_perm:[2,3,0,1] row_mask:0xf bank_mask:0xf
    v_add_f32_dpp v20, v20, v20 row_half_mirror row_mask:0xf bank_mask:0xf
    v_add_f32_dpp v21, v21, v21 row_half_mirror row_mask:0xf bank_mask:0xf
    v_add_f32_dpp v22, v22, v22 row_half_mirror row_mask:0xf bank_mask:0xf
    v_add_f32_dpp v23, v23, v23 row_half_mirror row_mask:0xf bank_mask:0xf
    ds_write_b128 v60, v[20:23] offset:16
    ds_read_b64 v[44:45], v41 offset:80
    s_add_u32 s45, s45, 1
    v_mov_b32 v58, s45
    s_lshl_b32 s53, s45, 2
    s_waitcnt vmcnt(6) lgkmcnt(0)
    v_readfirstlane_b32 s46, v44
    v_readfirstlane_b32 s52, v45
    s_cmp_lt_i32 s53, s46
    s_cbranch_scc1 L_wk12
    s_waitcnt vmcnt(3)
    s_cmp_le_i32 s53, s52
    s_cbranch_scc1 L_wk12
    s_waitcnt vmcnt(0)
L_wk12:
    buffer_load_dwordx4 v[244:247], v2, s[8:11], s38 offen offset:0 nt
    buffer_load_dwordx4 v[248:251], v2, s[8:11], s38 offen offset:128 nt
    buffer_load_dwordx4 v[252:255], v2, s[8:11], s38 offen offset:256 nt
    s_add_u32 s38, s38, s41
    ds_write_b32 v57, v58
    s_lshl_b32 s42, s40, 1
    s_add_i32 s42, s42, -2
    s_max_i32 s42, s42, 0
    s_mulk_i32 s42, 384
    v_add_u32 v40, s42, v3
    ds_read_b128 v[8:11], v40 offset:2560
    ds_read_b128 v[12:15], v40 offset:2688
    ds_read_b128 v[16:19], v40 offset:2816
    s_waitcnt lgkmcnt(0)
    v_mov_b32 v20, 0
    v_mov_b32 v21, 0
    v_mov_b32 v22, 0
    v_mov_b32 v23, 0
    v_dot2c_f32_bf16 v20, v160, v8
    v_dot2c_f32_bf16 v21, v172, v8
    v_dot2c_f32_bf16 v22, v184, v8
    v_dot2c_f32_bf16 v23, v196, v8
    v_dot2c_f32_bf16 v20, v161, v9
    v_dot2c_f32_bf16 v21, v173, v9
    v_dot2c_f32_bf16 v22, v185, v9
    v_dot2c_f32_bf16 v23, v197, v9
    v_dot2c_f32_bf16 v20, v162, v10
    v_dot2c_f32_bf16 v21, v174, v10
    v_dot2c_f32_bf16 v22, v186, v10
    v_dot2c_f32_bf16 v23, v198, v10
    v_dot2c_f32_bf16 v20, v163, v11
    v_dot2c_f32_bf16 v21, v175, v11
    v_dot2c_f32_bf16 v22, v187, v11
    v_dot2c_f32_bf16 v23, v199, v11
    v_dot2c_f32_bf16 v20, v164, v12
    v_dot2c_f32_bf16 v21, v176, v12
    v_dot2c_f32_bf16 v22, v188, v12
    v_dot2c_f32_bf16 v23, v200, v12
    v_dot2c_f32_bf16 v20, v165, v13
    v_dot2c_f32_bf16 v21, v177, v13
    v_dot2c_f32_bf16 v22, v189, v13
    v_dot2c_f32_bf16 v23, v201, v13
    v_dot2c_f32_bf16 v20, v166, v14
    v_dot2c_f32_bf16 v21, v178, v14
    v_dot2c_f32_bf16 v22, v190, v14
    v_dot2c_f32_bf16 v23, v202, v14
    v_dot2c_f32_bf16 v20, v167, v15
    v_dot2c_f32_bf16 v21, v179, v15
    v_dot2c_f32_bf16 v22, v191, v15
    v_dot2c_f32_bf16 v23, v203, v15
    v_dot2c_f32_bf16 v20, v168, v16
    v_dot2c_f32_bf16 v21, v180, v16
    v_dot2c_f32_bf16 v22, v192, v16
    v_dot2c_f32_bf16 v23, v204, v16
    v_dot2c_f32_bf16 v20, v169, v17
    v_dot2c_f32_bf16 v21, v181, v17
    v_dot2c_f32_bf16 v22, v193, v17
    v_dot2c_f32_bf16 v23, v205, v17
    v_dot2c_f32_bf16 v20, v170, v18
    v_dot2c_f32_bf16 v21, v182, v18
    v_dot2c_f32_bf16 v22, v194, v18
    v_dot2c_f32_bf16 v23, v206, v18
    v_dot2c_f32_bf16 v20, v171, v19
    v_dot2c_f32_bf16 v21, v183, v19
    v_dot2c_f32_bf16 v22, v195, v19
    v_dot2c_f32_bf16 v23, v207, v19
    v_add_f32_dpp v20, v20, v20 quad_perm:[1,0,3,2] row_mask:0xf bank_mask:0xf
    v_add_f32_dpp v21, v21, v21 quad_perm:[1,0,3,2] row_mask:0xf bank_mask:0xf
    v_add_f32_dpp v22, v22, v22 quad_perm:[1,0,3,2] row_mask:0xf bank_mask:0xf
    v_add_f32_dpp v23, v23, v23 quad_perm:[1,0,3,2] row_mask:0xf bank_mask:0xf
    v_add_f32_dpp v20, v20, v20 quad_perm:[2,3,0,1] row_mask:0xf bank_mask:0xf
    v_add_f32_dpp v21, v21, v21 quad_perm:[2,3,0,1] row_mask:0xf bank_mask:0xf
    v_add_f32_dpp v22, v22, v22 quad_perm:[2,3,0,1] row_mask:0xf bank_mask:0xf
    v_add_f32_dpp v23, v23, v23 quad_perm:[2,3,0,1] row_mask:0xf bank_mask:0xf
    v_add_f32_dpp v20, v20, v20 row_half_mirror row_mask:0xf bank_mask:0xf
    v_add_f32_dpp v21, v21, v21 row_half_mirror row_mask:0xf bank_mask:0xf
    v_add_f32_dpp v22, v22, v22 row_half_mirror row_mask:0xf bank_mask:0xf
    v_add_f32_dpp v23, v23, v23 row_half_mirror row_mask:0xf bank_mask:0xf
    ds_write_b128 v60, v[20:23] offset:32
    ds_read_b64 v[44:45], v41 offset:80
    s_add_u32 s45, s45, 1
    v_mov_b32 v58, s45
    s_lshl_b32 s53, s45, 2
    s_waitcnt vmcnt(6) lgkmcnt(0)
    v_readfirstlane_b32 s46, v44
    v_readfirstlane_b32 s52, v45
    s_cmp_lt_i32 s53, s46
    s_cbranch_scc1 L_wk13
    s_waitcnt vmcnt(3)
    s_cmp_le_i32 s53, s52
    s_cbranch_scc1 L_wk13
    s_waitcnt vmcnt(0)
L_wk13:
    s_cmp_eq_u32 s40, 2
    s_cselect_b32 s42, 22020096, 0
    s_add_u32 s38, s38, s42
    s_bitcmp1_b32 s40, 0
    s_cselect_b32 s38, s50, s38
    s_cselect_b32 s41, 393216, s41
    s_cmp_eq_u32 s40, 3
    s_cselect_b64 s[8:9], s[12:13], s[8:9]
    buffer_load_dwordx4 v[64:67], v2, s[8:11], s38 offen offset:0 nt
    buffer_load_dwordx4 v[68:71], v2, s[8:11], s38 offen offset:128 nt
    buffer_load_dwordx4 v[72:75], v2, s[8:11], s38 offen offset:256 nt
    s_add_u32 s38, s38, s41
    ds_write_b32 v57, v58
    ds_read_b64 v[44:45], v41 offset:80
    s_add_u32 s45, s45, 1
    v_mov_b32 v58, s45
    s_lshl_b32 s53, s45, 2
    s_waitcnt vmcnt(6) lgkmcnt(0)
    v_readfirstlane_b32 s46, v44
    v_readfirstlane_b32 s52, v45
    s_cmp_lt_i32 s53, s46
    s_cbranch_scc1 L_wk14
    s_waitcnt vmcnt(3)
    s_cmp_le_i32 s53, s52
    s_cbranch_scc1 L_wk14
    s_waitcnt vmcnt(0)
L_wk14:
    buffer_load_dwordx4 v[76:79], v2, s[8:11], s38 offen offset:0 nt
    buffer_load_dwordx4 v[80:83], v2, s[8:11], s38 offen offset:128 nt
    buffer_load_dwordx4 v[84:87], v2, s[8:11], s38 offen offset:256 nt
    s_add_u32 s38, s38, s41
    ds_write_b32 v57, v58
    ds_read_b64 v[44:45], v41 offset:80
    s_add_u32 s45, s45, 1
    v_mov_b32 v58, s45
    s_lshl_b32 s53, s45, 2
    s_waitcnt vmcnt(6) lgkmcnt(0)
    v_readfirstlane_b32 s46, v44
    v_readfirstlane_b32 s52, v45
    s_cmp_lt_i32 s53, s46
    s_cbranch_scc1 L_wk15
    s_waitcnt vmcnt(3)
    s_cmp_le_i32 s53, s52
    s_cbranch_scc1 L_wk15
    s_waitcnt vmcnt(0)
L_wk15:
    buffer_load_dwordx4 v[88:91], v2, s[8:11], s38 offen offset:0 nt
    buffer_load_dwordx4 v[92:95], v2, s[8:11], s38 offen offset:128 nt
    buffer_load_dwordx4 v[96:99], v2, s[8:11], s38 offen offset:256 nt
    s_add_u32 s38, s38, s41
    ds_write_b32 v57, v58
    v_mov_b32 v20, 0
    v_mov_b32 v21, 0
    v_mov_b32 v22, 0
    v_mov_b32 v23, 0
    v_dot2c_f32_bf16 v20, v208, v8
    v_dot2c_f32_bf16 v21, v220, v8
    v_dot2c_f32_bf16 v22, v232, v8
    v_dot2c_f32_bf16 v23, v244, v8
    v_dot2c_f32_bf16 v20, v209, v9
    v_dot2c_f32_bf16 v21, v221, v9
    v_dot2c_f32_bf16 v22, v233, v9
    v_dot2c_f32_bf16 v23, v245, v9
    v_dot2c_f32_bf16 v20, v210, v10
    v_dot2c_f32_bf16 v21, v222, v10
    v_dot2c_f32_bf16 v22, v234, v10
    v_dot2c_f32_bf16 v23, v246, v10
    v_dot2c_f32_bf16 v20, v211, v11
    v_dot2c_f32_bf16 v21, v223, v11
    v_dot2c_f32_bf16 v22, v235, v11
    v_dot2c_f32_bf16 v23, v247, v11
    v_dot2c_f32_bf16 v20, v212, v12
    v_dot2c_f32_bf16 v21, v224, v12
    v_dot2c_f32_bf16 v22, v236, v12
    v_dot2c_f32_bf16 v23, v248, v12
    v_dot2c_f32_bf16 v20, v213, v13
    v_dot2c_f32_bf16 v21, v225, v13
    v_dot2c_f32_bf16 v22, v237, v13
    v_dot2c_f32_bf16 v23, v249, v13
    v_dot2c_f32_bf16 v20, v214, v14
    v_dot2c_f32_bf16 v21, v226, v14
    v_dot2c_f32_bf16 v22, v238, v14
    v_dot2c_f32_bf16 v23, v250, v14
    v_dot2c_f32_bf16 v20, v215, v15
    v_dot2c_f32_bf16 v21, v227, v15
    v_dot2c_f32_bf16 v22, v239, v15
    v_dot2c_f32_bf16 v23, v251, v15
    v_dot2c_f32_bf16 v20, v216, v16
    v_dot2c_f32_bf16 v21, v228, v16
    v_dot2c_f32_bf16 v22, v240, v16
    v_dot2c_f32_bf16 v23, v252, v16
    v_dot2c_f32_bf16 v20, v217, v17
    v_dot2c_f32_bf16 v21, v229, v17
    v_dot2c_f32_bf16 v22, v241, v17
    v_dot2c_f32_bf16 v23, v253, v17
    v_dot2c_f32_bf16 v20, v218, v18
    v_dot2c_f32_bf16 v21, v230, v18
    v_dot2c_f32_bf16 v22, v242, v18
    v_dot2c_f32_bf16 v23, v254, v18
    v_dot2c_f32_bf16 v20, v219, v19
    v_dot2c_f32_bf16 v21, v231, v19
    v_dot2c_f32_bf16 v22, v243, v19
    v_dot2c_f32_bf16 v23, v255, v19
    v_add_f32_dpp v20, v20, v20 quad_perm:[1,0,3,2] row_mask:0xf bank_mask:0xf
    v_add_f32_dpp v21, v21, v21 quad_perm:[1,0,3,2] row_mask:0xf bank_mask:0xf
    v_add_f32_dpp v22, v22, v22 quad_perm:[1,0,3,2] row_mask:0xf bank_mask:0xf
    v_add_f32_dpp v23, v23, v23 quad_perm:[1,0,3,2] row_mask:0xf bank_mask:0xf
    v_add_f32_dpp v20, v20, v20 quad_perm:[2,3,0,1] row_mask:0xf bank_mask:0xf
    v_add_f32_dpp v21, v21, v21 quad_perm:[2,3,0,1] row_mask:0xf bank_mask:0xf
    v_add_f32_dpp v22, v22, v22 quad_perm:[2,3,0,1] row_mask:0xf bank_mask:0xf
    v_add_f32_dpp v23, v23, v23 quad_perm:[2,3,0,1] row_mask:0xf bank_mask:0xf
    v_add_f32_dpp v20, v20, v20 row_half_mirror row_mask:0xf bank_mask:0xf
    v_add_f32_dpp v21, v21, v21 row_half_mirror row_mask:0xf bank_mask:0xf
    v_add_f32_dpp v22, v22, v22 row_half_mirror row_mask:0xf bank_mask:0xf
    v_add_f32_dpp v23, v23, v23 row_half_mirror row_mask:0xf bank_mask:0xf
    ds_write_b128 v60, v[20:23] offset:48
    s_add_u32 s40, s40, 1
    v_add_u32 v60, 64, v60
    s_cmp_lt_u32 s40, 4
    s_cbranch_scc1 L_kloop
    s_waitcnt lgkmcnt(0)
    ds_read_b128 v[8:11], v61
    ds_read_b128 v[12:15], v61 offset:128
    v_subrev_u32 v60, 128, v60
    s_mov_b32 s40, 0
    v_mov_b32 v28, 0
    v_mov_b32 v29, 0
    v_mov_b32 v30, 0
    v_mov_b32 v31, 0
    v_mov_b32 v32, 0
    v_mov_b32 v33, 0
    v_mov_b32 v34, 0
    v_mov_b32 v35, 0
    v_mov_b32 v36, 0
    v_mov_b32 v37, 0
    v_mov_b32 v38, 0
    v_mov_b32 v39, 0
    s_mov_b32 s47, 0x2a
    s_mov_b32 s48, 0x10154
    s_waitcnt lgkmcnt(0)
    v_cvt_pk_bf16_f32 v9, v8, v9
    v_cvt_pk_bf16_f32 v11, v10, v11
    v_cvt_pk_bf16_f32 v13, v12, v13
    v_cvt_pk_bf16_f32 v15, v14, v15
    v_lshlrev_b32 v8, 16, v9
    v_lshlrev_b32 v10, 16, v11
    v_lshlrev_b32 v12, 16, v13
    v_lshlrev_b32 v14, 16, v15
    v_and_b32 v9, 0xffff0000, v9
    v_and_b32 v11, 0xffff0000, v11
    v_and_b32 v13, 0xffff0000, v13
    v_and_b32 v15, 0xffff0000, v15
    v_mul_f32 v8, 0x3d93cd3a, v8
    v_mul_f32 v10, 0x3d93cd3a, v10
    v_mul_f32 v12, 0x3d93cd3a, v12
    v_mul_f32 v14, 0x3d93cd3a, v14
    v_mul_f32 v9, 0x3d93cd3a, v9
    v_mul_f32 v11, 0x3d93cd3a, v11
    v_mul_f32 v13, 0x3d93cd3a, v13
    v_mul_f32 v15, 0x3d93cd3a, v15
    v_cvt_pk_bf16_f32 v9, v8, v9
    v_cvt_pk_bf16_f32 v11, v10, v11
    v_cvt_pk_bf16_f32 v13, v12, v13
    v_cvt_pk_bf16_f32 v15, v14, v15
    v_lshlrev_b32 v8, 16, v9
    v_lshlrev_b32 v10, 16, v11
    v_lshlrev_b32 v12, 16, v13
    v_lshlrev_b32 v14, 16, v15
    v_and_b32 v9, 0xffff0000, v9
    v_and_b32 v11, 0xffff0000, v11
    v_and_b32 v13, 0xffff0000, v13
    v_and_b32 v15, 0xffff0000, v15
    v_mov_b32 v43, 0xff7fffff
    v_max3_f32 v16, v8, v9, v43
    v_max3_f32 v18, v12, v13, v43
    v_max3_f32 v16, v10, v11, v16
    v_max3_f32 v18, v14, v15, v18
    s_nop 0
    v_max_f32_dpp v16, v16, v16 quad_perm:[1,0,3,2] row_mask:0xf bank_mask:0xf
    v_max_f32_dpp v18, v18, v18 quad_perm:[1,0,3,2] row_mask:0xf bank_mask:0xf
    s_nop 0
    v_max_f32_dpp v16, v16, v16 quad_perm:[2,3,0,1] row_mask:0xf bank_mask:0xf
    v_max_f32_dpp v18, v18, v18 row_ror:8 row_mask:0xf bank_mask:0xf
    s_nop 0
    v_max_f32_dpp v16, v16, v16 row_half_mirror row_mask:0xf bank_mask:0xf
    v_mov_b32 v19, v18
    s_nop 0
    v_max_f32_dpp v16, v16, v16 row_ror:8 row_mask:0xf bank_mask:0xf
    v_permlane16_swap_b32 v19, v18
    v_mov_b32 v17, v16
    v_max_f32 v18, v19, v18
    s_nop 0
    v_permlane16_swap_b32 v17, v16
    v_mov_b32 v19, v18
    v_max_f32 v16, v17, v16
    s_nop 0
    v_permlane32_swap_b32 v19, v18
    v_mov_b32 v17, v16
    v_max_f32 v18, v19, v18
    s_nop 0
    v_permlane32_swap_b32 v17, v16
    v_max_f32 v16, v17, v16
    v_sub_f32 v8, v8, v16
    v_sub_f32 v9, v9, v16
    v_sub_f32 v10, v10, v16
    v_sub_f32 v11, v11, v16
    v_sub_f32 v12, v12, v18
    v_sub_f32 v13, v13, v18
    v_sub_f32 v14, v14, v18
    v_sub_f32 v15, v15, v18
    v_mul_f32 v8, 0x3fb8aa3b, v8
    v_mul_f32 v9, 0x3fb8aa3b, v9
    v_mul_f32 v10, 0x3fb8aa3b, v10
    v_mul_f32 v11, 0x3fb8aa3b, v11
    v_mul_f32 v12, 0x3fb8aa3b, v12
    v_mul_f32 v13, 0x3fb8aa3b, v13
    v_mul_f32 v14, 0x3fb8aa3b, v14
    v_mul_f32 v15, 0x3fb8aa3b, v15
    v_exp_f32 v8, v8
    v_exp_f32 v9, v9
    v_exp_f32 v10, v10
    v_exp_f32 v11, v11
    v_exp_f32 v12, v12
    v_exp_f32 v13, v13
    v_exp_f32 v14, v14
    v_exp_f32 v15, v15
    v_cvt_pk_bf16_f32 v20, v8, v8
    v_cvt_pk_bf16_f32 v21, v9, v9
    v_cvt_pk_bf16_f32 v22, v10, v10
    v_cvt_pk_bf16_f32 v23, v11, v11
    v_cvt_pk_bf16_f32 v24, v12, v12
    v_cvt_pk_bf16_f32 v25, v13, v13
    v_cvt_pk_bf16_f32 v26, v14, v14
    v_cvt_pk_bf16_f32 v27, v15, v15
    ds_write_b128 v61, v[20:23]
    ds_write_b128 v61, v[24:27] offset:128
    v_add_f32 v8, v8, v9
    v_add_f32 v12, v12, v13
    v_add_f32 v10, v10, v11
    v_add_f32 v14, v14, v15
    v_add_f32 v17, v8, v10
    v_add_f32 v19, v12, v14
    s_nop 0
    v_add_f32_dpp v17, v17, v17 quad_perm:[1,0,3,2] row_mask:0xf bank_mask:0xf
    v_add_f32_dpp v19, v19, v19 quad_perm:[1,0,3,2] row_mask:0xf bank_mask:0xf
    s_nop 0
    v_add_f32_dpp v17, v17, v17 quad_perm:[2,3,0,1] row_mask:0xf bank_mask:0xf
    v_add_f32_dpp v19, v19, v19 row_ror:8 row_mask:0xf bank_mask:0xf
    s_nop 0
    v_add_f32_dpp v17, v17, v17 row_half_mirror row_mask:0xf bank_mask:0xf
    v_mov_b32 v12, v19
    s_nop 0
    v_add_f32_dpp v17, v17, v17 row_ror:8 row_mask:0xf bank_mask:0xf
    v_permlane16_swap_b32 v12, v19
    v_mov_b32 v8, v17
    v_add_f32 v19, v12, v19
    s_nop 0
    v_permlane16_swap_b32 v8, v17
    v_mov_b32 v12, v19
    v_add_f32 v17, v8, v17
    s_nop 0
    v_permlane32_swap_b32 v12, v19
    v_mov_b32 v8, v17
    v_add_f32 v19, v12, v19
    s_nop 0
    v_permlane32_swap_b32 v8, v17
    v_add_f32 v17, v8, v17
    s_mov_b64 exec, 0xff
    ds_write_b64 v46, v[18:19]
    s_mov_b64 exec, 1
    ds_write_b64 v46, v[16:17] offset:128
    s_waitcnt lgkmcnt(0)
    ds_add_u32 v41, v47 offset:20
    s_mov_b64 exec, -1
L_vloop:
    ds_read_b64 v[44:45], v41 offset:80
    ds_read_b128 v[20:23], v60
    s_add_u32 s45, s45, 1
    v_mov_b32 v58, s45
    s_lshl_b32 s53, s45, 2
    s_waitcnt vmcnt(6) lgkmcnt(0)
    v_readfirstlane_b32 s46, v44
    v_readfirstlane_b32 s52, v45
    s_cmp_lt_i32 s53, s46
    s_cbranch_scc1 L_wv0
    s_waitcnt vmcnt(3)
    s_cmp_le_i32 s53, s52
    s_cbranch_scc1 L_wv0
    s_waitcnt vmcnt(0)
L_wv0:
    buffer_load_dwordx4 v[100:103], v2, s[8:11], s38 offen offset:0 nt
    buffer_load_dwordx4 v[104:107], v2, s[8:11], s38 offen offset:128 nt
    buffer_load_dwordx4 v[108:111], v2, s[8:11], s38 offen offset:256 nt
    s_add_u32 s38, s38, s41
    ds_write_b32 v57, v58
    v_and_b32 v48, v20, v4
    v_and_b32 v49, v20, v5
    v_and_b32 v50, v20, v6
    v_and_b32 v51, v20, v7
    s_nop 1
    v_mfma_f32_16x16x32_bf16 v[28:31], v[48:51], v[64:67], v[28:31]
    v_mfma_f32_16x16x32_bf16 v[32:35], v[48:51], v[68:71], v[32:35]
    v_mfma_f32_16x16x32_bf16 v[36:39], v[48:51], v[72:75], v[36:39]
    ds_read_b64 v[44:45], v41 offset:80
    v_and_b32 v52, v21, v4
    v_and_b32 v53, v21, v5
    v_and_b32 v54, v21, v6
    v_and_b32 v55, v21, v7
    s_add_u32 s45, s45, 1
    v_mov_b32 v58, s45
    s_lshl_b32 s53, s45, 2
    s_waitcnt vmcnt(6) lgkmcnt(0)
    v_readfirstlane_b32 s46, v44
    v_readfirstlane_b32 s52, v45
    s_cmp_eq_u32 s40, 15
    s_cbranch_scc1 L_wv1
    s_cmp_lt_i32 s53, s46
    s_cbranch_scc1 L_wv1
    s_waitcnt vmcnt(3)
    s_cmp_le_i32 s53, s52
    s_cbranch_scc1 L_wv1
    s_waitcnt vmcnt(0)
L_wv1:
    s_bitcmp1_b32 s47, s40
    s_cselect_b32 s42, 22020096, 0
    s_add_u32 s38, s38, s42
    s_cmp_eq_u32 s40, 7
    s_cselect_b32 s38, s39, s38
    s_cselect_b32 s41, 98304, s41
    s_cmp_eq_u32 s40, 15
    s_cbranch_scc1 L_dm1
    buffer_load_dwordx4 v[64:67], v2, s[8:11], s38 offen offset:0 nt
    buffer_load_dwordx4 v[68:71], v2, s[8:11], s38 offen offset:128 nt
    buffer_load_dwordx4 v[72:75], v2, s[8:11], s38 offen offset:256 nt
    s_add_u32 s38, s38, s41
L_dm1:
L_dj1:
    ds_write_b32 v57, v58
    v_mfma_f32_16x16x32_bf16 v[28:31], v[52:55], v[76:79], v[28:31]
    v_mfma_f32_16x16x32_bf16 v[32:35], v[52:55], v[80:83], v[32:35]
    v_mfma_f32_16x16x32_bf16 v[36:39], v[52:55], v[84:87], v[36:39]
    ds_read_b64 v[44:45], v41 offset:80
    v_and_b32 v48, v22, v4
    v_and_b32 v49, v22, v5
    v_and_b32 v50, v22, v6
    v_and_b32 v51, v22, v7
    s_add_u32 s45, s45, 1
    v_mov_b32 v58, s45
    s_lshl_b32 s53, s45, 2
    s_waitcnt vmcnt(6) lgkmcnt(0)
    v_readfirstlane_b32 s46, v44
    v_readfirstlane_b32 s52, v45
    s_cmp_eq_u32 s40, 15
    s_cbranch_scc0 L_wv2_n
    s_waitcnt vmcnt(3)
    s_branch L_wv2
L_wv2_n:
    s_cmp_lt_i32 s53, s46
    s_cbranch_scc1 L_wv2
    s_waitcnt vmcnt(3)
    s_cmp_le_i32 s53, s52
    s_cbranch_scc1 L_wv2
    s_waitcnt vmcnt(0)
L_wv2:
    s_cmp_eq_u32 s40, 15
    s_cbranch_scc1 L_dm2
    buffer_load_dwordx4 v[76:79], v2, s[8:11], s38 offen offset:0 nt
    buffer_load_dwordx4 v[80:83], v2, s[8:11], s38 offen offset:128 nt
    buffer_load_dwordx4 v[84:87], v2, s[8:11], s38 offen offset:256 nt
    s_add_u32 s38, s38, s41
    s_branch L_dj2
L_dm2:
    s_add_u32 m0, s49, 5120
    s_add_u32 s51, s51, 40960
    buffer_load_dwordx4 v112, s[16:19], s51 offen lds
    s_add_u32 m0, s49, 6144
    s_nop 0
    buffer_load_dwordx4 v113, s[16:19], s51 offen lds
    s_add_u32 m0, s49, 7168
    s_nop 0
    buffer_load_dwordx4 v114, s[16:19], s51 offen lds
    s_add_u32 m0, s49, 8192
    s_nop 0
    buffer_load_dwordx4 v115, s[16:19], s51 offen lds
    s_add_u32 m0, s49, 9216
    s_nop 0
    buffer_load_dwordx4 v116, s[16:19], s51 offen lds
L_dj2:
    ds_write_b32 v57, v58
    v_mfma_f32_16x16x32_bf16 v[28:31], v[48:51], v[88:91], v[28:31]
    v_mfma_f32_16x16x32_bf16 v[32:35], v[48:51], v[92:95], v[32:35]
    v_mfma_f32_16x16x32_bf16 v[36:39], v[48:51], v[96:99], v[36:39]
    ds_read_b64 v[44:45], v41 offset:80
    v_and_b32 v52, v23, v4
    v_and_b32 v53, v23, v5
    v_and_b32 v54, v23, v6
    v_and_b32 v55, v23, v7
    s_add_u32 s45, s45, 1
    v_mov_b32 v58, s45
    s_lshl_b32 s53, s45, 2
    s_waitcnt vmcnt(6) lgkmcnt(0)
    v_readfirstlane_b32 s46, v44
    v_readfirstlane_b32 s52, v45
    s_cmp_eq_u32 s40, 15
    s_cbranch_scc0 L_wv3_n
    s_waitcnt vmcnt(5)
    s_branch L_wv3
L_wv3_n:
    s_cmp_lt_i32 s53, s46
    s_cbranch_scc1 L_wv3
    s_waitcnt vmcnt(3)
    s_cmp_le_i32 s53, s52
    s_cbranch_scc1 L_wv3
    s_waitcnt vmcnt(0)
L_wv3:
    s_cmp_eq_u32 s40, 15
    v_mfma_f32_16x16x32_bf16 v[28:31], v[52:55], v[100:103], v[28:31]
    v_mfma_f32_16x16x32_bf16 v[32:35], v[52:55], v[104:107], v[32:35]
    v_mfma_f32_16x16x32_bf16 v[36:39], v[52:55], v[108:111], v[36:39]
    s_cbranch_scc1 L_flush
    buffer_load_dwordx4 v[88:91], v2, s[8:11], s38 offen offset:0 nt
    buffer_load_dwordx4 v[92:95], v2, s[8:11], s38 offen offset:128 nt
    buffer_load_dwordx4 v[96:99], v2, s[8:11], s38 offen offset:256 nt
    s_add_u32 s38, s38, s41
    ds_write_b32 v57, v58
    s_add_u32 s40, s40, 1
    v_add_u32 v60, 16, v60
    s_bitcmp1_b32 s48, s40
    s_cbranch_scc0 L_vloop
L_flush:
    s_mov_b32 exec_lo, 0x00ff00ff
    s_mov_b32 exec_hi, 0xff00ff00
    s_cmp_eq_u32 s40, 15
    s_nop 2
    ds_write_b128 v42, v[28:31]
    ds_write_b128 v42, v[32:35] offset:256
    ds_write_b128 v42, v[36:39] offset:512
    s_mov_b64 exec, 1
    ds_add_u32 v56, v47
    s_mov_b64 exec, -1
    s_cbranch_scc1 L_sdone
    v_add_u32 v42, 6144, v42
    v_add_u32 v56, 4, v56
    s_cmp_eq_u32 s40, 8
    s_cselect_b32 s42, 256, 0
    v_subrev_u32 v60, s42, v60
    v_mov_b32 v28, 0
    v_mov_b32 v29, 0
    v_mov_b32 v30, 0
    v_mov_b32 v31, 0
    v_mov_b32 v32, 0
    v_mov_b32 v33, 0
    v_mov_b32 v34, 0
    v_mov_b32 v35, 0
    v_mov_b32 v36, 0
    v_mov_b32 v37, 0
    v_mov_b32 v38, 0
    v_mov_b32 v39, 0
    v_add_u32 v13, 0, v1
    v_mul_u32_u24 v14, 6554, v13
    v_lshrrev_b32 v14, 16, v14
    v_mul_u32_u24 v15, 10, v14
    v_sub_u32 v15, v13, v15
    v_mul_u32_u24 v14, 1280, v14
    v_lshl_add_u32 v112, v15, 4, v14
    v_add_u32 v13, 64, v1
    v_mul_u32_u24 v14, 6554, v13
    v_lshrrev_b32 v14, 16, v14
    v_mul_u32_u24 v15, 10, v14
    v_sub_u32 v15, v13, v15
    v_mul_u32_u24 v14, 1280, v14
    v_lshl_add_u32 v113, v15, 4, v14
    v_add_u32 v13, 128, v1
    v_mul_u32_u24 v14, 6554, v13
    v_lshrrev_b32 v14, 16, v14
    v_mul_u32_u24 v15, 10, v14
    v_sub_u32 v15, v13, v15
    v_mul_u32_u24 v14, 1280, v14
    v_lshl_add_u32 v114, v15, 4, v14
    v_add_u32 v13, 192, v1
    v_mul_u32_u24 v14, 6554, v13
    v_lshrrev_b32 v14, 16, v14
    v_mul_u32_u24 v15, 10, v14
    v_sub_u32 v15, v13, v15
    v_mul_u32_u24 v14, 1280, v14
    v_lshl_add_u32 v115, v15, 4, v14
    v_add_u32 v13, 256, v1
    v_mul_u32_u24 v14, 6554, v13
    v_lshrrev_b32 v14, 16, v14
    v_mul_u32_u24 v15, 10, v14
    v_sub_u32 v15, v13, v15
    v_mul_u32_u24 v14, 1280, v14
    v_lshl_add_u32 v116, v15, 4, v14
    s_nop 0
    s_branch L_vloop
L_sdone:
    ds_write_b32 v57, v58
    s_mov_b32 s60, 0
    s_mov_b32 s61, 1
L_proj:
    v_and_b32 v120, 63, v0
    v_lshrrev_b32 v122, 4, v120
    v_bfe_u32 v121, v120, 2, 2
    v_lshl_add_u32 v121, v122, 3, v121
    v_mul_u32_u24 v121, 160, v121
    v_and_b32 v123, 3, v120
    v_lshl_add_u32 v121, v123, 3, v121
    s_lshl_b32 s42, s3, 5
    s_add_u32 s42, s42, 56288
    v_add_u32 v121, s42, v121
    v_and_b32 v125, 1, v120
    v_lshlrev_b32 v122, 4, v122
    v_mul_u32_u24 v123, 384, v125
    v_add_u32 v123, v123, v122
    v_lshl_add_u32 v124, v125, 6, v122
    v_lshl_add_u32 v122, v125, 7, v122
    v_mov_b32 v125, 0
    v_mov_b32 v126, 0xffffff00
    ds_read_b32 v127, v125 offset:5540
    ds_read_b128 v[184:187], v122 offset:4480
    ds_read_b128 v[188:191], v122 offset:4544
    s_lshl3_add_u32 s62, s36, s37
    s_mul_i32 s62, s62, 5
    s_add_u32 s62, s62, s3
    s_lshl_b32 s62, s62, 7
    s_add_u32 s62, s62, 786304
    s_waitcnt lgkmcnt(0)
    v_readfirstlane_b32 s63, v127
    v_mov_b32 v127, s61
    s_lshl_b32 s43, s60, 2
    s_bfe_u32 s56, s63, 0x80000
    s_bfe_u32 s57, s63, 0x80008
    s_bfe_u32 s58, s63, 0x80010
    s_bfe_u32 s59, s63, 0x80018
    s_waitcnt vmcnt(0)
    s_mov_b64 exec, 1
    ds_add_u32 v125, v127 offset:5532
    s_mov_b64 exec, -1
L_tw1:
    ds_read_b32 v127, v125 offset:5532
    s_waitcnt lgkmcnt(0)
    v_readfirstlane_b32 s42, v127
    s_add_u32 s42, s42, s43
    s_cmp_lt_u32 s42, 4
    s_cbranch_scc1 L_tw1
    ds_read_b64_tr_b16 v[152:153], v121 offset:30720
    ds_read_b64_tr_b16 v[154:155], v121 offset:31360
    ds_read_b64_tr_b16 v[156:157], v121 offset:35840
    ds_read_b64_tr_b16 v[158:159], v121 offset:36480
    ds_read_b64_tr_b16 v[128:129], v121 offset:0
    ds_read_b64_tr_b16 v[130:131], v121 offset:640
    ds_read_b64_tr_b16 v[132:133], v121 offset:5120
    ds_read_b64_tr_b16 v[134:135], v121 offset:5760
    ds_read_b64_tr_b16 v[136:137], v121 offset:10240
    ds_read_b64_tr_b16 v[138:139], v121 offset:10880
    ds_read_b64_tr_b16 v[140:141], v121 offset:15360
    ds_read_b64_tr_b16 v[142:143], v121 offset:16000
    ds_read_b64_tr_b16 v[144:145], v121 offset:20480
    ds_read_b64_tr_b16 v[146:147], v121 offset:21120
    ds_read_b64_tr_b16 v[148:149], v121 offset:25600
    ds_read_b64_tr_b16 v[150:151], v121 offset:26240
    s_waitcnt lgkmcnt(12)
    v_mfma_f32_16x16x32_bf16 v[192:195], v[152:155], v[184:187], 0
    v_mfma_f32_16x16x32_bf16 v[192:195], v[156:159], v[188:191], v[192:195]
L_tw2:
    ds_read_b32 v127, v125 offset:5536
    ds_read_b128 v[160:163], v123 offset:4736
    ds_read_b128 v[164:167], v123 offset:4800
    ds_read_b128 v[168:171], v123 offset:4864
    ds_read_b128 v[172:175], v123 offset:4928
    ds_read_b128 v[176:179], v123 offset:4992
    ds_read_b128 v[180:183], v123 offset:5056
    s_waitcnt lgkmcnt(6)
    v_readfirstlane_b32 s42, v127
    s_or_b32 s42, s42, s60
    s_cbranch_scc0 L_tw2
    s_waitcnt lgkmcnt(5)
    v_mfma_f32_16x16x32_bf16 v[192:195], v[128:131], v[160:163], v[192:195]
    s_waitcnt lgkmcnt(4)
    v_mfma_f32_16x16x32_bf16 v[192:195], v[132:135], v[164:167], v[192:195]
    s_waitcnt lgkmcnt(3)
    v_mfma_f32_16x16x32_bf16 v[192:195], v[136:139], v[168:171], v[192:195]
    s_waitcnt lgkmcnt(2)
    v_mfma_f32_16x16x32_bf16 v[192:195], v[140:143], v[172:175], v[192:195]
    s_waitcnt lgkmcnt(1)
    v_mfma_f32_16x16x32_bf16 v[192:195], v[144:147], v[176:179], v[192:195]
    s_waitcnt lgkmcnt(0)
    v_mfma_f32_16x16x32_bf16 v[192:195], v[148:151], v[180:183], v[192:195]
    s_mov_b32 exec_lo, 0x00030003
    s_mov_b32 exec_hi, 0x00030003
    s_cmp_lg_u32 s60, 0
    v_mov_b32 v127, 1
    s_nop 3
    v_and_or_b32 v192, v192, v126, s56
    v_and_or_b32 v193, v193, v126, s57
    v_and_or_b32 v194, v194, v126, s58
    v_and_or_b32 v195, v195, v126, s59
    s_cbranch_scc1 L_projdry
    buffer_store_dwordx4 v[192:195], v124, s[24:27], s62 offen sc1
    s_mov_b64 exec, 1
    s_waitcnt vmcnt(0)
    ds_add_u32 v125, v127 offset:5544
    s_endpgm
L_ctl:
    s_barrier
    s_load_dwordx2 s[24:25], s[0:1], 80
    s_mov_b32 s26, 4194304
    s_mov_b32 s27, 0x20000
    s_mov_b32 s42, 983040
    s_waitcnt lgkmcnt(0)
    s_load_dword s38, s[24:25], s42
    v_and_b32 v0, 63, v0
    v_lshlrev_b32 v1, 2, v0
    v_mov_b32 v2, 0
    v_mul_u32_u24 v3, 4352, v0
    s_and_b32 s43, s2, 7
    s_lshl_b32 s39, s43, 7
    s_add_u32 s39, s39, 987136
    s_lshr_b32 s49, s2, 3
    s_lshl2_add_u32 s40, s49, s39
    s_mul_i32 s46, s43, 4352
    s_add_u32 s46, s46, 1048576
    s_lshl1_add_u32 s47, s43, 320
    s_mov_b32 s51, 0
    s_mov_b32 s48, 32768
    s_mov_b32 s53, 0
    s_waitcnt lgkmcnt(0)
    s_mul_i32 s38, s38, 1664525
    s_add_u32 s38, s38, 1013904223
    s_lshl_b32 s38, s38, 16
    v_mov_b32 v15, s38
    s_mov_b32 s60, 1
    s_mov_b32 s61, 0
    s_branch L_proj
L_projdry:
    s_mov_b64 exec, -1
    s_mov_b32 s60, 0
    v_lshlrev_b32 v12, 7, v0
    s_sub_u32 s62, s62, 512
    s_mov_b64 exec, 31
    buffer_load_dword v13, v12, s[24:27], s62 offen
    s_mov_b64 exec, -1
L_ctl_l:
    ds_read_b128 v[16:19], v2 offset:5568
    s_waitcnt lgkmcnt(0)
    v_add3_u32 v4, v16, v17, v18
    v_add_u32 v4, v4, v19
    s_nop 0
    v_readfirstlane_b32 s41, v4
    s_or_b32 s42, s38, s48
    v_or_b32 v6, s42, v4
    s_mov_b64 exec, 1
    buffer_store_dword v6, v2, s[24:27], s40 offen
    s_mov_b32 exec_lo, -1
    buffer_load_dword v5, v1, s[24:27], s39 offen sc1
    s_cmp_eq_u32 s51, 0
    s_cbranch_scc1 L_ctl_ng
    s_mov_b32 exec_lo, 0xffffff
    buffer_load_dword v6, v3, s[24:27], s51 offen sc1
    s_waitcnt vmcnt(0)
    v_cmp_eq_u32 vcc, s38, v6
    s_bcnt1_i32_b64 s42, vcc
    s_lshl1_add_u32 s42, s42, s52
    s_sub_i32 s42, s42, s50
    s_mul_i32 s42, s42, 8
    s_add_i32 s53, s53, s42
    s_ashr_i32 s53, s53, 1
    s_add_i32 s42, s53, 8
    s_ashr_i32 s42, s42, 4
    s_max_i32 s42, s42, -5
    s_min_i32 s42, s42, 6
    s_add_i32 s42, s42, 32
    s_lshl_b32 s48, s42, 10
    s_mov_b32 exec_lo, -1
L_ctl_ng:
    s_waitcnt vmcnt(0)
    v_xor_b32 v5, s38, v5
    s_nop 0
    v_readfirstlane_b32 s44, v5
    v_cmp_gt_u32 vcc, 0x10000, v5
    v_and_b32 v5, 0x1ff, v5
    s_nop 0
    v_cndmask_b32 v5, 0, v5, vcc
    s_bfe_u32 s44, s44, 0x6000a
    s_nop 0
    v_add_u32_dpp v5, v5, v5 quad_perm:[1,0,3,2] row_mask:0xf bank_mask:0xf
    s_nop 1
    v_add_u32_dpp v5, v5, v5 quad_perm:[2,3,0,1] row_mask:0xf bank_mask:0xf
    s_nop 1
    v_add_u32_dpp v5, v5, v5 row_half_mirror row_mask:0xf bank_mask:0xf
    s_nop 1
    v_add_u32_dpp v5, v5, v5 row_mirror row_mask:0xf bank_mask:0xf
    s_nop 0
    v_readlane_b32 s42, v5, 0
    v_readlane_b32 s43, v5, 16
    s_add_u32 s50, s42, s43
    s_lshr_b32 s50, s50, 5
    s_add_u32 s44, s44, s50
    s_add_i32 s42, s44, -14
    s_add_i32 s43, s44, -6
    s_cmp_eq_u32 vcc_lo, -1
    s_cselect_b32 s43, s43, 0x1000
    s_cselect_b32 s42, s42, 0
    v_mov_b32 v8, s42
    v_mov_b32 v9, s43
    ds_write_b64 v2, v[8:9] offset:5584
    s_cmp_eq_u32 s49, 0
    s_cbranch_scc0 L_ctl_nl
L_ctl_post:
    s_cmp_ge_u32 s50, s47
    s_cbranch_scc0 L_ctl_np
    s_mov_b64 exec, 1
    buffer_store_dword v15, v2, s[24:27], s46 offen sc1
    s_add_u32 s46, s46, 34816
    s_add_u32 s47, s47, 16
    s_branch L_ctl_post
L_ctl_np:
    s_sub_i32 s42, s50, 332
    s_lshr_b32 s51, s42, 4
    s_lshl4_add_u32 s52, s51, 316
    s_mul_i32 s51, s51, 34816
    s_add_u32 s51, s51, 1048576
    s_cmp_lt_u32 s42, 124
    s_cselect_b32 s51, s51, 0
L_ctl_nl:
    s_mov_b64 exec, -1
    s_cmp_lt_u32 s41, 488
    s_cbranch_scc1 L_ctl_l
    s_or_b32 s42, s38, s48
    s_or_b32 s42, s42, 0x1ff
    v_mov_b32 v4, s42
    v_mov_b32 v8, 0
    v_mov_b32 v9, 0x1000
    s_mov_b64 exec, 1
    buffer_store_dword v4, v2, s[24:27], s40 offen
    ds_write_b64 v2, v[8:9] offset:5584
    s_mov_b64 exec, -1
    s_branch L_proj
L_helper:
    s_setprio 2
    s_load_dwordx2 s[4:5], s[0:1], 0
    s_load_dwordx2 s[24:25], s[0:1], 80
    s_mov_b32 s26, 4194304
    s_mov_b32 s27, 0x20000
    s_cmp_lt_u32 s37, 6
    s_cselect_b32 s42, 24, 48
    s_load_dwordx2 s[16:17], s[0:1], s42
    s_load_dwordx2 s[32:33], s[0:1], 64
    s_movk_i32 s6, 2560
    s_mov_b32 s7, 0x20000
    s_movk_i32 s34, 2560
    s_mov_b32 s35, 0x20000
    s_mov_b32 s19, 0x20000
    s_cmp_lt_u32 s36, 24
    s_cselect_b32 s18, 1966080, 0
    s_movk_i32 s40, 3072
    s_cmp_lt_u32 s37, 6
    s_cselect_b32 s18, 7864320, s18
    s_cselect_b32 s40, 12288, s40
    s_cbranch_scc1 L_isq
    s_sub_u32 s57, s37, 6
    s_lshl_b32 s39, s36, 7
    s_branch L_isq_done
L_isq:
    s_cmp_ge_u32 s37, 3
    s_cselect_b32 s57, 1, 0
    s_sub_u32 s42, s36, s57
    s_mul_i32 s39, s42, 3
    s_add_u32 s39, s39, s37
    s_lshl_b32 s39, s39, 7
L_isq_done:
    s_mul_i32 s42, s40, 320
    s_mul_i32 s42, s42, s57
    s_add_u32 s39, s39, s42
    v_mov_b32 v6, 0
    v_and_b32 v7, 15, v0
    v_lshlrev_b32 v7, 2, v7
    ds_write_b32 v7, v6 offset:5504
    v_mul_u32_u24 v1, 40, v0
    v_lshrrev_b32 v6, 3, v0
    v_and_b32 v7, 7, v0
    v_and_b32 v8, 2, v6
    v_xor_b32 v7, v7, v8
    v_lshlrev_b32 v7, 4, v7
    v_mul_lo_u32 v6, v6, s40
    s_lshl_b32 s42, s40, 3
    s_sub_u32 s42, s42, 1024
    v_add_u32 v2, v6, v7
    v_xor_b32 v7, 64, v7
    v_add3_u32 v3, v6, v7, s42
    s_lshl_b32 s42, s42, 1
    v_add_u32 v4, s42, v2
    v_add_u32 v5, s42, v3
    s_lshl_b32 s40, s40, 5
    s_mov_b32 m0, 15360
    s_mov_b32 s42, 983040
    s_waitcnt lgkmcnt(0)
    s_load_dword s38, s[24:25], s42
    buffer_load_dwordx4 v[8:11], v1, s[4:7], 0 offen
    buffer_load_dwordx4 v[12:15], v1, s[4:7], 0 offen offset:16
    buffer_load_dwordx2 v[16:17], v1, s[4:7], 0 offen offset:32
    s_barrier
    buffer_load_dwordx4 v2, s[16:19], s39 offen offset:0 nt lds
    buffer_load_dwordx4 v3, s[16:19], s39 offen offset:1024 nt lds
    buffer_load_dwordx4 v4, s[16:19], s39 offen offset:2048 nt lds
    buffer_load_dwordx4 v5, s[16:19], s39 offen offset:3072 nt lds
    s_addk_i32 m0, 0x1000
    s_add_u32 s39, s39, s40
    buffer_load_dwordx4 v2, s[16:19], s39 offen offset:0 nt lds
    buffer_load_dwordx4 v3, s[16:19], s39 offen offset:1024 nt lds
    buffer_load_dwordx4 v4, s[16:19], s39 offen offset:2048 nt lds
    buffer_load_dwordx4 v5, s[16:19], s39 offen offset:3072 nt lds
    s_addk_i32 m0, 0x1000
    s_add_u32 s39, s39, s40
    buffer_load_dwordx4 v2, s[16:19], s39 offen offset:0 nt lds
    buffer_load_dwordx4 v3, s[16:19], s39 offen offset:1024 nt lds
    buffer_load_dwordx4 v4, s[16:19], s39 offen offset:2048 nt lds
    buffer_load_dwordx4 v5, s[16:19], s39 offen offset:3072 nt lds
    s_addk_i32 m0, 0x1000
    s_add_u32 s39, s39, s40
    buffer_load_dwordx4 v2, s[16:19], s39 offen offset:0 nt lds
    buffer_load_dwordx4 v3, s[16:19], s39 offen offset:1024 nt lds
    buffer_load_dwordx4 v4, s[16:19], s39 offen offset:2048 nt lds
    buffer_load_dwordx4 v5, s[16:19], s39 offen offset:3072 nt lds
    s_addk_i32 m0, 0x1000
    s_add_u32 s39, s39, s40
    buffer_load_dwordx4 v2, s[16:19], s39 offen offset:0 nt lds
    buffer_load_dwordx4 v3, s[16:19], s39 offen offset:1024 nt lds
    buffer_load_dwordx4 v4, s[16:19], s39 offen offset:2048 nt lds
    buffer_load_dwordx4 v5, s[16:19], s39 offen offset:3072 nt lds
    s_addk_i32 m0, 0x1000
    s_add_u32 s39, s39, s40
    buffer_load_dwordx4 v2, s[16:19], s39 offen offset:0 nt lds
    buffer_load_dwordx4 v3, s[16:19], s39 offen offset:1024 nt lds
    buffer_load_dwordx4 v4, s[16:19], s39 offen offset:2048 nt lds
    buffer_load_dwordx4 v5, s[16:19], s39 offen offset:3072 nt lds
    s_addk_i32 m0, 0x1000
    s_add_u32 s39, s39, s40
    buffer_load_dwordx4 v2, s[16:19], s39 offen offset:0 nt lds
    buffer_load_dwordx4 v3, s[16:19], s39 offen offset:1024 nt lds
    buffer_load_dwordx4 v4, s[16:19], s39 offen offset:2048 nt lds
    buffer_load_dwordx4 v5, s[16:19], s39 offen offset:3072 nt lds
    s_addk_i32 m0, 0x1000
    s_add_u32 s39, s39, s40
    buffer_load_dwordx4 v2, s[16:19], s39 offen offset:0 nt lds
    buffer_load_dwordx4 v3, s[16:19], s39 offen offset:1024 nt lds
    buffer_load_dwordx4 v4, s[16:19], s39 offen offset:2048 nt lds
    buffer_load_dwordx4 v5, s[16:19], s39 offen offset:3072 nt lds
    s_addk_i32 m0, 0x1000
    s_add_u32 s39, s39, s40
    buffer_load_dwordx4 v2, s[16:19], s39 offen offset:0 nt lds
    buffer_load_dwordx4 v3, s[16:19], s39 offen offset:1024 nt lds
    buffer_load_dwordx4 v4, s[16:19], s39 offen offset:2048 nt lds
    buffer_load_dwordx4 v5, s[16:19], s39 offen offset:3072 nt lds
    s_addk_i32 m0, 0x1000
    s_add_u32 s39, s39, s40
    buffer_load_dwordx4 v2, s[16:19], s39 offen offset:0 nt lds
    buffer_load_dwordx4 v3, s[16:19], s39 offen offset:1024 nt lds
    buffer_load_dwordx4 v4, s[16:19], s39 offen offset:2048 nt lds
    buffer_load_dwordx4 v5, s[16:19], s39 offen offset:3072 nt lds
    s_mov_b32 s50, 0xcccccccc
    s_mov_b32 s51, s50
    s_mov_b32 s52, 0xf0f0f0f0
    s_mov_b32 s53, s52
    s_mov_b32 s54, 0xff00ff00
    s_mov_b32 s55, s54
    v_lshrrev_b32 v18, 4, v0
    v_bfe_u32 v19, v0, 2, 2
    v_lshl_add_u32 v20, v18, 3, v19
    v_lshlrev_b32 v20, 7, v20
    v_and_b32 v21, 3, v0
    v_lshl_add_u32 v20, v21, 3, v20
    v_bfe_u32 v21, v0, 3, 2
    v_xor_b32 v22, 0, v21
    v_lshl_add_u32 v2, v22, 5, v20
    v_xor_b32 v22, 1, v21
    v_lshl_add_u32 v3, v22, 5, v20
    v_xor_b32 v22, 2, v21
    v_lshl_add_u32 v4, v22, 5, v20
    v_xor_b32 v22, 3, v21
    v_lshl_add_u32 v5, v22, 5, v20
    v_and_b32 v19, 1, v0
    v_mul_u32_u24 v19, 1280, v19
    s_mul_i32 s42, s57, 640
    v_lshlrev_b32 v18, 4, v18
    v_add3_u32 v6, v19, v18, s42
    v_lshlrev_b32 v7, 4, v0
    s_waitcnt vmcnt(40)
    v_lshlrev_b32 v20, 16, v8
    v_and_b32 v21, 0xffff0000, v8
    v_lshlrev_b32 v22, 16, v9
    v_and_b32 v23, 0xffff0000, v9
    v_lshlrev_b32 v24, 16, v10
    v_and_b32 v25, 0xffff0000, v10
    v_lshlrev_b32 v26, 16, v11
    v_and_b32 v27, 0xffff0000, v11
    v_lshlrev_b32 v28, 16, v12
    v_and_b32 v29, 0xffff0000, v12
    v_lshlrev_b32 v30, 16, v13
    v_and_b32 v31, 0xffff0000, v13
    v_lshlrev_b32 v32, 16, v14
    v_and_b32 v33, 0xffff0000, v14
    v_lshlrev_b32 v34, 16, v15
    v_and_b32 v35, 0xffff0000, v15
    v_lshlrev_b32 v36, 16, v16
    v_and_b32 v37, 0xffff0000, v16
    v_lshlrev_b32 v38, 16, v17
    v_and_b32 v39, 0xffff0000, v17
    v_pk_add_f32 v[60:61], v[20:21], v[22:23]
    v_pk_add_f32 v[62:63], v[24:25], v[26:27]
    v_pk_add_f32 v[60:61], v[60:61], v[28:29]
    v_pk_add_f32 v[62:63], v[62:63], v[30:31]
    v_pk_add_f32 v[60:61], v[60:61], v[32:33]
    v_pk_add_f32 v[62:63], v[62:63], v[34:35]
    v_pk_add_f32 v[60:61], v[60:61], v[36:37]
    v_pk_add_f32 v[62:63], v[62:63], v[38:39]
    v_pk_add_f32 v[60:61], v[60:61], v[62:63]
    v_add_f32 v60, v60, v61
    s_nop 1
    v_add_f32_dpp v60, v60, v60 quad_perm:[1,0,3,2] row_mask:0xf bank_mask:0xf
    s_nop 1
    v_add_f32_dpp v60, v60, v60 quad_perm:[2,3,0,1] row_mask:0xf bank_mask:0xf
    s_nop 1
    v_add_f32_dpp v60, v60, v60 row_half_mirror row_mask:0xf bank_mask:0xf
    s_nop 1
    v_add_f32_dpp v60, v60, v60 row_mirror row_mask:0xf bank_mask:0xf
    v_mov_b32 v62, v60
    s_nop 1
    v_permlane16_swap_b32 v62, v60
    v_add_f32 v60, v62, v60
    v_mul_f32 v64, 0x3acccccd, v60
    v_pk_add_f32 v[40:41], v[20:21], v[64:65] op_sel_hi:[1,0] neg_lo:[0,1] neg_hi:[0,1]
    v_pk_add_f32 v[42:43], v[22:23], v[64:65] op_sel_hi:[1,0] neg_lo:[0,1] neg_hi:[0,1]
    v_pk_add_f32 v[44:45], v[24:25], v[64:65] op_sel_hi:[1,0] neg_lo:[0,1] neg_hi:[0,1]
    v_pk_add_f32 v[46:47], v[26:27], v[64:65] op_sel_hi:[1,0] neg_lo:[0,1] neg_hi:[0,1]
    v_pk_add_f32 v[48:49], v[28:29], v[64:65] op_sel_hi:[1,0] neg_lo:[0,1] neg_hi:[0,1]
    v_pk_add_f32 v[50:51], v[30:31], v[64:65] op_sel_hi:[1,0] neg_lo:[0,1] neg_hi:[0,1]
    v_pk_add_f32 v[52:53], v[32:33], v[64:65] op_sel_hi:[1,0] neg_lo:[0,1] neg_hi:[0,1]
    v_pk_add_f32 v[54:55], v[34:35], v[64:65] op_sel_hi:[1,0] neg_lo:[0,1] neg_hi:[0,1]
    v_pk_add_f32 v[56:57], v[36:37], v[64:65] op_sel_hi:[1,0] neg_lo:[0,1] neg_hi:[0,1]
    v_pk_add_f32 v[58:59], v[38:39], v[64:65] op_sel_hi:[1,0] neg_lo:[0,1] neg_hi:[0,1]
    v_cvt_pk_bf16_f32 v64, v64, v64
    v_and_b32 v64, 0xffff0000, v64
    v_pk_mul_f32 v[60:61], v[40:41], v[40:41]
    v_pk_mul_f32 v[62:63], v[42:43], v[42:43]
    v_pk_fma_f32 v[60:61], v[44:45], v[44:45], v[60:61]
    v_pk_fma_f32 v[62:63], v[46:47], v[46:47], v[62:63]
    v_pk_fma_f32 v[60:61], v[48:49], v[48:49], v[60:61]
    v_pk_fma_f32 v[62:63], v[50:51], v[50:51], v[62:63]
    v_pk_fma_f32 v[60:61], v[52:53], v[52:53], v[60:61]
    v_pk_fma_f32 v[62:63], v[54:55], v[54:55], v[62:63]
    v_pk_fma_f32 v[60:61], v[56:57], v[56:57], v[60:61]
    v_pk_fma_f32 v[62:63], v[58:59], v[58:59], v[62:63]
    v_pk_add_f32 v[60:61], v[60:61], v[62:63]
    v_add_f32 v60, v60, v61
    v_pk_add_f32 v[20:21], v[20:21], v[64:65] op_sel_hi:[1,0] neg_lo:[0,1] neg_hi:[0,1]
    v_pk_add_f32 v[22:23], v[22:23], v[64:65] op_sel_hi:[1,0] neg_lo:[0,1] neg_hi:[0,1]
    v_pk_add_f32 v[24:25], v[24:25], v[64:65] op_sel_hi:[1,0] neg_lo:[0,1] neg_hi:[0,1]
    v_pk_add_f32 v[26:27], v[26:27], v[64:65] op_sel_hi:[1,0] neg_lo:[0,1] neg_hi:[0,1]
    v_pk_add_f32 v[28:29], v[28:29], v[64:65] op_sel_hi:[1,0] neg_lo:[0,1] neg_hi:[0,1]
    v_pk_add_f32 v[30:31], v[30:31], v[64:65] op_sel_hi:[1,0] neg_lo:[0,1] neg_hi:[0,1]
    v_pk_add_f32 v[32:33], v[32:33], v[64:65] op_sel_hi:[1,0] neg_lo:[0,1] neg_hi:[0,1]
    v_pk_add_f32 v[34:35], v[34:35], v[64:65] op_sel_hi:[1,0] neg_lo:[0,1] neg_hi:[0,1]
    v_pk_add_f32 v[36:37], v[36:37], v[64:65] op_sel_hi:[1,0] neg_lo:[0,1] neg_hi:[0,1]
    v_pk_add_f32 v[38:39], v[38:39], v[64:65] op_sel_hi:[1,0] neg_lo:[0,1] neg_hi:[0,1]
    v_add_f32_dpp v60, v60, v60 quad_perm:[1,0,3,2] row_mask:0xf bank_mask:0xf
    s_nop 1
    v_add_f32_dpp v60, v60, v60 quad_perm:[2,3,0,1] row_mask:0xf bank_mask:0xf
    s_nop 1
    v_add_f32_dpp v60, v60, v60 row_half_mirror row_mask:0xf bank_mask:0xf
    s_nop 1
    v_add_f32_dpp v60, v60, v60 row_mirror row_mask:0xf bank_mask:0xf
    v_mov_b32 v62, v60
    s_nop 1
    v_permlane16_swap_b32 v62, v60
    v_add_f32 v60, v62, v60
    v_cvt_pk_bf16_f32 v8, v20, v21
    v_cvt_pk_bf16_f32 v9, v22, v23
    v_cvt_pk_bf16_f32 v10, v24, v25
    v_cvt_pk_bf16_f32 v11, v26, v27
    v_cvt_pk_bf16_f32 v12, v28, v29
    v_cvt_pk_bf16_f32 v13, v30, v31
    v_cvt_pk_bf16_f32 v14, v32, v33
    v_cvt_pk_bf16_f32 v15, v34, v35
    v_cvt_pk_bf16_f32 v16, v36, v37
    v_cvt_pk_bf16_f32 v17, v38, v39
    v_mul_f32 v60, 0x3acccccd, v60
    v_cvt_pk_bf16_f32 v60, v60, v60
    v_and_b32 v60, 0xffff0000, v60
    v_add_f32 v60, 0x3727c5ac, v60
    v_cvt_pk_bf16_f32 v60, v60, v60
    v_and_b32 v60, 0xffff0000, v60
    v_sqrt_f32 v60, v60
    s_nop 0
    v_cvt_pk_bf16_f32 v60, v60, v60
    v_and_b32 v60, 0xffff0000, v60
    v_rcp_f32 v66, v60
    v_lshlrev_b32 v20, 16, v8
    v_and_b32 v21, 0xffff0000, v8
    v_lshlrev_b32 v22, 16, v9
    v_and_b32 v23, 0xffff0000, v9
    v_lshlrev_b32 v24, 16, v10
    v_and_b32 v25, 0xffff0000, v10
    v_lshlrev_b32 v26, 16, v11
    v_and_b32 v27, 0xffff0000, v11
    v_lshlrev_b32 v28, 16, v12
    v_and_b32 v29, 0xffff0000, v12
    v_lshlrev_b32 v30, 16, v13
    v_and_b32 v31, 0xffff0000, v13
    v_lshlrev_b32 v32, 16, v14
    v_and_b32 v33, 0xffff0000, v14
    v_lshlrev_b32 v34, 16, v15
    v_and_b32 v35, 0xffff0000, v15
    v_lshlrev_b32 v36, 16, v16
    v_and_b32 v37, 0xffff0000, v16
    v_lshlrev_b32 v38, 16, v17
    v_and_b32 v39, 0xffff0000, v17
    v_pk_mul_f32 v[20:21], v[20:21], v[66:67] op_sel_hi:[1,0]
    v_pk_mul_f32 v[22:23], v[22:23], v[66:67] op_sel_hi:[1,0]
    v_pk_mul_f32 v[24:25], v[24:25], v[66:67] op_sel_hi:[1,0]
    v_pk_mul_f32 v[26:27], v[26:27], v[66:67] op_sel_hi:[1,0]
    v_pk_mul_f32 v[28:29], v[28:29], v[66:67] op_sel_hi:[1,0]
    v_pk_mul_f32 v[30:31], v[30:31], v[66:67] op_sel_hi:[1,0]
    v_pk_mul_f32 v[32:33], v[32:33], v[66:67] op_sel_hi:[1,0]
    v_pk_mul_f32 v[34:35], v[34:35], v[66:67] op_sel_hi:[1,0]
    v_pk_mul_f32 v[36:37], v[36:37], v[66:67] op_sel_hi:[1,0]
    v_pk_mul_f32 v[38:39], v[38:39], v[66:67] op_sel_hi:[1,0]
    v_cvt_pk_bf16_f32 v8, v20, v21
    v_cvt_pk_bf16_f32 v9, v22, v23
    v_cvt_pk_bf16_f32 v10, v24, v25
    v_cvt_pk_bf16_f32 v11, v26, v27
    v_cvt_pk_bf16_f32 v12, v28, v29
    v_cvt_pk_bf16_f32 v13, v30, v31
    v_cvt_pk_bf16_f32 v14, v32, v33
    v_cvt_pk_bf16_f32 v15, v34, v35
    v_cvt_pk_bf16_f32 v16, v36, v37
    v_cvt_pk_bf16_f32 v17, v38, v39
    ds_write_b64 v1, v[8:9] offset:0
    ds_write_b64 v1, v[10:11] offset:8
    ds_write_b64 v1, v[12:13] offset:16
    ds_write_b64 v1, v[14:15] offset:24
    ds_write_b64 v1, v[16:17] offset:32
    s_waitcnt lgkmcnt(0)
    ds_read_b128 v[20:23], v6 offset:0
    ds_read_b128 v[24:27], v6 offset:64
    ds_read_b128 v[28:31], v6 offset:128
    ds_read_b128 v[32:35], v6 offset:192
    ds_read_b128 v[36:39], v6 offset:256
    ds_read_b128 v[40:43], v6 offset:320
    ds_read_b128 v[44:47], v6 offset:384
    ds_read_b128 v[48:51], v6 offset:448
    ds_read_b128 v[52:55], v6 offset:512
    ds_read_b128 v[56:59], v6 offset:576
    s_waitcnt vmcnt(36)
    ds_read_b64_tr_b16 v[80:81], v2 offset:15360
    ds_read_b64_tr_b16 v[82:83], v2 offset:15872
    ds_read_b64_tr_b16 v[84:85], v3 offset:15360
    ds_read_b64_tr_b16 v[86:87], v3 offset:15872
    ds_read_b64_tr_b16 v[88:89], v4 offset:15360
    ds_read_b64_tr_b16 v[90:91], v4 offset:15872
    ds_read_b64_tr_b16 v[92:93], v5 offset:15360
    ds_read_b64_tr_b16 v[94:95], v5 offset:15872
    s_waitcnt vmcnt(32)
    ds_read_b64_tr_b16 v[96:97], v2 offset:19456
    ds_read_b64_tr_b16 v[98:99], v2 offset:19968
    ds_read_b64_tr_b16 v[100:101], v3 offset:19456
    ds_read_b64_tr_b16 v[102:103], v3 offset:19968
    ds_read_b64_tr_b16 v[104:105], v4 offset:19456
    ds_read_b64_tr_b16 v[106:107], v4 offset:19968
    ds_read_b64_tr_b16 v[108:109], v5 offset:19456
    ds_read_b64_tr_b16 v[110:111], v5 offset:19968
    s_waitcnt lgkmcnt(8)
    v_mfma_f32_16x16x32_bf16 v[60:63], v[80:83], v[20:23], 0
    v_mfma_f32_16x16x32_bf16 v[64:67], v[84:87], v[20:23], 0
    v_mfma_f32_16x16x32_bf16 v[68:71], v[88:91], v[20:23], 0
    v_mfma_f32_16x16x32_bf16 v[72:75], v[92:95], v[20:23], 0
    s_waitcnt vmcnt(28)
    ds_read_b64_tr_b16 v[80:81], v2 offset:23552
    ds_read_b64_tr_b16 v[82:83], v2 offset:24064
    ds_read_b64_tr_b16 v[84:85], v3 offset:23552
    ds_read_b64_tr_b16 v[86:87], v3 offset:24064
    ds_read_b64_tr_b16 v[88:89], v4 offset:23552
    ds_read_b64_tr_b16 v[90:91], v4 offset:24064
    ds_read_b64_tr_b16 v[92:93], v5 offset:23552
    ds_read_b64_tr_b16 v[94:95], v5 offset:24064
    s_waitcnt lgkmcnt(8)
    v_mfma_f32_16x16x32_bf16 v[60:63], v[96:99], v[24:27], v[60:63]
    v_mfma_f32_16x16x32_bf16 v[64:67], v[100:103], v[24:27], v[64:67]
    v_mfma_f32_16x16x32_bf16 v[68:71], v[104:107], v[24:27], v[68:71]
    v_mfma_f32_16x16x32_bf16 v[72:75], v[108:111], v[24:27], v[72:75]
    s_waitcnt vmcnt(24)
    ds_read_b64_tr_b16 v[96:97], v2 offset:27648
    ds_read_b64_tr_b16 v[98:99], v2 offset:28160
    ds_read_b64_tr_b16 v[100:101], v3 offset:27648
    ds_read_b64_tr_b16 v[102:103], v3 offset:28160
    ds_read_b64_tr_b16 v[104:105], v4 offset:27648
    ds_read_b64_tr_b16 v[106:107], v4 offset:28160
    ds_read_b64_tr_b16 v[108:109], v5 offset:27648
    ds_read_b64_tr_b16 v[110:111], v5 offset:28160
    s_waitcnt lgkmcnt(8)
    v_mfma_f32_16x16x32_bf16 v[60:63], v[80:83], v[28:31], v[60:63]
    v_mfma_f32_16x16x32_bf16 v[64:67], v[84:87], v[28:31], v[64:67]
    v_mfma_f32_16x16x32_bf16 v[68:71], v[88:91], v[28:31], v[68:71]
    v_mfma_f32_16x16x32_bf16 v[72:75], v[92:95], v[28:31], v[72:75]
    s_waitcnt vmcnt(20)
    ds_read_b64_tr_b16 v[80:81], v2 offset:31744
    ds_read_b64_tr_b16 v[82:83], v2 offset:32256
    ds_read_b64_tr_b16 v[84:85], v3 offset:31744
    ds_read_b64_tr_b16 v[86:87], v3 offset:32256
    ds_read_b64_tr_b16 v[88:89], v4 offset:31744
    ds_read_b64_tr_b16 v[90:91], v4 offset:32256
    ds_read_b64_tr_b16 v[92:93], v5 offset:31744
    ds_read_b64_tr_b16 v[94:95], v5 offset:32256
    s_waitcnt lgkmcnt(8)
    v_mfma_f32_16x16x32_bf16 v[60:63], v[96:99], v[32:35], v[60:63]
    v_mfma_f32_16x16x32_bf16 v[64:67], v[100:103], v[32:35], v[64:67]
    v_mfma_f32_16x16x32_bf16 v[68:71], v[104:107], v[32:35], v[68:71]
    v_mfma_f32_16x16x32_bf16 v[72:75], v[108:111], v[32:35], v[72:75]
    s_waitcnt vmcnt(16)
    ds_read_b64_tr_b16 v[96:97], v2 offset:35840
    ds_read_b64_tr_b16 v[98:99], v2 offset:36352
    ds_read_b64_tr_b16 v[100:101], v3 offset:35840
    ds_read_b64_tr_b16 v[102:103], v3 offset:36352
    ds_read_b64_tr_b16 v[104:105], v4 offset:35840
    ds_read_b64_tr_b16 v[106:107], v4 offset:36352
    ds_read_b64_tr_b16 v[108:109], v5 offset:35840
    ds_read_b64_tr_b16 v[110:111], v5 offset:36352
    s_waitcnt lgkmcnt(8)
    v_mfma_f32_16x16x32_bf16 v[60:63], v[80:83], v[36:39], v[60:63]
    v_mfma_f32_16x16x32_bf16 v[64:67], v[84:87], v[36:39], v[64:67]
    v_mfma_f32_16x16x32_bf16 v[68:71], v[88:91], v[36:39], v[68:71]
    v_mfma_f32_16x16x32_bf16 v[72:75], v[92:95], v[36:39], v[72:75]
    s_waitcnt vmcnt(12)
    ds_read_b64_tr_b16 v[80:81], v2 offset:39936
    ds_read_b64_tr_b16 v[82:83], v2 offset:40448
    ds_read_b64_tr_b16 v[84:85], v3 offset:39936
    ds_read_b64_tr_b16 v[86:87], v3 offset:40448
    ds_read_b64_tr_b16 v[88:89], v4 offset:39936
    ds_read_b64_tr_b16 v[90:91], v4 offset:40448
    ds_read_b64_tr_b16 v[92:93], v5 offset:39936
    ds_read_b64_tr_b16 v[94:95], v5 offset:40448
    s_waitcnt lgkmcnt(8)
    v_mfma_f32_16x16x32_bf16 v[60:63], v[96:99], v[40:43], v[60:63]
    v_mfma_f32_16x16x32_bf16 v[64:67], v[100:103], v[40:43], v[64:67]
    v_mfma_f32_16x16x32_bf16 v[68:71], v[104:107], v[40:43], v[68:71]
    v_mfma_f32_16x16x32_bf16 v[72:75], v[108:111], v[40:43], v[72:75]
    s_waitcnt vmcnt(8)
    ds_read_b64_tr_b16 v[96:97], v2 offset:44032
    ds_read_b64_tr_b16 v[98:99], v2 offset:44544
    ds_read_b64_tr_b16 v[100:101], v3 offset:44032
    ds_read_b64_tr_b16 v[102:103], v3 offset:44544
    ds_read_b64_tr_b16 v[104:105], v4 offset:44032
    ds_read_b64_tr_b16 v[106:107], v4 offset:44544
    ds_read_b64_tr_b16 v[108:109], v5 offset:44032
    ds_read_b64_tr_b16 v[110:111], v5 offset:44544
    s_waitcnt lgkmcnt(8)
    v_mfma_f32_16x16x32_bf16 v[60:63], v[80:83], v[44:47], v[60:63]
    v_mfma_f32_16x16x32_bf16 v[64:67], v[84:87], v[44:47], v[64:67]
    v_mfma_f32_16x16x32_bf16 v[68:71], v[88:91], v[44:47], v[68:71]
    v_mfma_f32_16x16x32_bf16 v[72:75], v[92:95], v[44:47], v[72:75]
    s_waitcnt vmcnt(4)
    ds_read_b64_tr_b16 v[80:81], v2 offset:48128
    ds_read_b64_tr_b16 v[82:83], v2 offset:48640
    ds_read_b64_tr_b16 v[84:85], v3 offset:48128
    ds_read_b64_tr_b16 v[86:87], v3 offset:48640
    ds_read_b64_tr_b16 v[88:89], v4 offset:48128
    ds_read_b64_tr_b16 v[90:91], v4 offset:48640
    ds_read_b64_tr_b16 v[92:93], v5 offset:48128
    ds_read_b64_tr_b16 v[94:95], v5 offset:48640
    s_waitcnt lgkmcnt(8)
    v_mfma_f32_16x16x32_bf16 v[60:63], v[96:99], v[48:51], v[60:63]
    v_mfma_f32_16x16x32_bf16 v[64:67], v[100:103], v[48:51], v[64:67]
    v_mfma_f32_16x16x32_bf16 v[68:71], v[104:107], v[48:51], v[68:71]
    v_mfma_f32_16x16x32_bf16 v[72:75], v[108:111], v[48:51], v[72:75]
    s_waitcnt vmcnt(0)
    ds_read_b64_tr_b16 v[96:97], v2 offset:52224
    ds_read_b64_tr_b16 v[98:99], v2 offset:52736
    ds_read_b64_tr_b16 v[100:101], v3 offset:52224
    ds_read_b64_tr_b16 v[102:103], v3 offset:52736
    ds_read_b64_tr_b16 v[104:105], v4 offset:52224
    ds_read_b64_tr_b16 v[106:107], v4 offset:52736
    ds_read_b64_tr_b16 v[108:109], v5 offset:52224
    ds_read_b64_tr_b16 v[110:111], v5 offset:52736
    s_waitcnt lgkmcnt(8)
    v_mfma_f32_16x16x32_bf16 v[60:63], v[80:83], v[52:55], v[60:63]
    v_mfma_f32_16x16x32_bf16 v[64:67], v[84:87], v[52:55], v[64:67]
    v_mfma_f32_16x16x32_bf16 v[68:71], v[88:91], v[52:55], v[68:71]
    v_mfma_f32_16x16x32_bf16 v[72:75], v[92:95], v[52:55], v[72:75]
    s_waitcnt lgkmcnt(0)
    v_mfma_f32_16x16x32_bf16 v[60:63], v[96:99], v[56:59], v[60:63]
    v_mfma_f32_16x16x32_bf16 v[64:67], v[100:103], v[56:59], v[64:67]
    v_mfma_f32_16x16x32_bf16 v[68:71], v[104:107], v[56:59], v[68:71]
    v_mfma_f32_16x16x32_bf16 v[72:75], v[108:111], v[56:59], v[72:75]
    s_mul_i32 s38, s38, 1664525
    s_add_u32 s38, s38, 1013904223
    s_lshl3_add_u32 s31, s36, s37
    s_lshl_b32 s31, s31, 10
    s_getreg_b32 s28, hwreg(HW_REG_XCC_ID, 0, 4)
    v_mov_b32 v9, s38
    v_mov_b32 v11, s28
    s_mov_b32 s45, 0x100000
    s_mov_b32 s29, 6
    s_mov_b32 s30, 0
    s_mov_b32 s41, 0
    v_cndmask_b32 v60, v60, v62, s[54:55]
    v_cndmask_b32 v61, v61, v63, s[54:55]
    v_cndmask_b32 v64, v64, v66, s[54:55]
    v_cndmask_b32 v65, v65, v67, s[54:55]
    v_cndmask_b32 v68, v68, v70, s[54:55]
    v_cndmask_b32 v69, v69, v71, s[54:55]
    v_cndmask_b32 v72, v72, v74, s[54:55]
    v_cndmask_b32 v73, v73, v75, s[54:55]
    v_cndmask_b32 v60, v60, v64, s[50:51]
    v_cndmask_b32 v61, v61, v65, s[50:51]
    v_cndmask_b32 v68, v68, v72, s[50:51]
    v_cndmask_b32 v69, v69, v73, s[50:51]
    v_cndmask_b32 v8, v60, v68, s[52:53]
    v_cndmask_b32 v10, v61, v69, s[52:53]
    buffer_store_dwordx4 v[8:11], v7, s[24:27], s31 offen
    v_bfe_u32 v16, v0, 1, 2
    v_lshlrev_b32 v16, 5, v16
    v_lshrrev_b32 v15, 4, v0
    v_lshl_add_u32 v16, v15, 3, v16
    v_bfe_u32 v15, v0, 3, 1
    v_lshl_add_u32 v16, v15, 2, v16
    v_and_b32 v17, 1, v0
    v_lshl_add_u32 v13, v17, 7, v16
    v_mov_b32 v5, 0
L_qround:
    s_xor_b32 s42, s36, s41
    s_lshl_b32 s49, s42, 13
    s_add_u32 s43, s49, 4096
    s_lshr_b32 s42, s42, 3
    s_add_u32 s42, s42, 1
    s_mulk_i32 s42, 384
    v_mad_u32_u24 v12, v17, s42, v16
L_pollq:
    buffer_load_dwordx4 v[20:23], v7, s[24:27], s49 offen offset:0 sc1
    buffer_load_dwordx4 v[24:27], v7, s[24:27], s49 offen offset:1024 sc1
    buffer_load_dwordx4 v[28:31], v7, s[24:27], s49 offen offset:2048 sc1
    buffer_load_dwordx4 v[32:35], v7, s[24:27], s49 offen offset:3072 sc1
    buffer_load_dwordx4 v[36:39], v7, s[24:27], s43 offen offset:0 sc1
    buffer_load_dwordx4 v[40:43], v7, s[24:27], s43 offen offset:1024 sc1
    buffer_load_dwordx4 v[44:47], v7, s[24:27], s43 offen offset:2048 sc1
    buffer_load_dwordx4 v[48:51], v7, s[24:27], s43 offen offset:3072 sc1
    s_waitcnt vmcnt(0)
    v_xor_b32 v14, s38, v21
    v_bitop3_b32 v14, v25, s38, v14 bitop3:0xbe
    v_bitop3_b32 v14, v29, s38, v14 bitop3:0xbe
    v_bitop3_b32 v14, v33, s38, v14 bitop3:0xbe
    v_bitop3_b32 v14, v37, s38, v14 bitop3:0xbe
    v_bitop3_b32 v14, v41, s38, v14 bitop3:0xbe
    v_bitop3_b32 v14, v45, s38, v14 bitop3:0xbe
    v_bitop3_b32 v14, v49, s38, v14 bitop3:0xbe
    v_cmp_ne_u32 vcc, 0, v14
    s_nop 3
    s_cbranch_vccz L_pollq_ok
    s_sub_u32 s29, s29, 1
    s_cmp_lg_u32 s29, 0
    s_cbranch_scc1 L_pollq_more
    buffer_store_dwordx4 v[8:11], v7, s[24:27], s31 offen sc1
L_pollq_more:
    s_sub_u32 s45, s45, 1
    s_cbranch_scc0 L_pollq
L_giveup:
    v_mov_b32 v15, 2
    ds_write_b32 v5, v15 offset:5528
    ds_write_b32 v5, v15 offset:5536
    s_endpgm
L_pollq_ok:
    v_add_f32 v20, v20, v32
    v_add_f32 v22, v22, v34
    v_add_f32 v24, v24, v36
    v_add_f32 v26, v26, v38
    v_add_f32 v28, v28, v40
    v_add_f32 v30, v30, v42
    s_cmp_eq_u32 s41, 0
    s_cselect_b32 exec_lo, -1, 0xaaaaaaaa
    s_cselect_b32 exec_hi, -1, 0xaaaaaaaa
    v_cvt_pk_bf16_f32 v20, v20, v22
    ds_write_b32 v12, v20 offset:2560
    v_cvt_pk_bf16_f32 v24, v24, v26
    ds_write_b32 v12, v24 offset:2688
    v_cvt_pk_bf16_f32 v28, v28, v30
    ds_write_b32 v12, v28 offset:2816
    s_mov_b64 exec, -1
    v_mov_b32 v15, 1
    ds_write_b32 v5, v15 offset:5528
    v_xor_b32 v15, s28, v23
    v_bitop3_b32 v15, v27, s28, v15 bitop3:0xbe
    v_bitop3_b32 v15, v31, s28, v15 bitop3:0xbe
    v_bitop3_b32 v15, v35, s28, v15 bitop3:0xbe
    v_bitop3_b32 v15, v39, s28, v15 bitop3:0xbe
    v_bitop3_b32 v15, v43, s28, v15 bitop3:0xbe
    v_bitop3_b32 v15, v47, s28, v15 bitop3:0xbe
    v_bitop3_b32 v15, v51, s28, v15 bitop3:0xbe
    s_nop 0
    v_readfirstlane_b32 s42, v15
    s_or_b32 s30, s30, s42
    s_nop 2
    s_cbranch_scc0 L_near
    buffer_store_dwordx4 v[8:11], v7, s[24:27], s31 offen sc1
L_near:
    s_cmp_lg_u32 s41, 0
    s_cbranch_scc1 L_qnext
    v_add_f32 v44, v44, v48
    v_add_f32 v46, v46, v50
    v_maximum3_f32 v44, v44, 0, 0
    v_maximum3_f32 v46, v46, 0, 0
    v_cvt_pk_bf16_f32 v44, v44, v46
    ds_write_b32 v13, v44 offset:4480
L_qnext:
    s_add_u32 s41, s41, 8
    s_cmp_lt_u32 s41, 32
    s_cbranch_scc1 L_qround
    v_mov_b32 v15, 2
    ds_write_b32 v5, v9 offset:5540
    ds_write_b32 v5, v15 offset:5528
    v_and_b32 v6, 3, v0
    v_lshlrev_b32 v6, 3, v6
    v_and_b32 v125, 0x70, v7
    v_and_b32 v12, 0x1f0, v7
    v_lshlrev_b32 v13, 1, v0
    v_add_u32 v13, 384, v13
    v_and_b32 v9, 31, v0
    v_mul_u32_u24 v9, 5120, v9
    v_lshrrev_b32 v10, 5, v0
    v_lshl_add_u32 v14, v10, 4, v9
    v_add_u32 v14, 0x40000000, v14
    v_lshlrev_b32 v15, 3, v10
    v_lshlrev_b32 v16, 2, v0
    v_add_u32 v16, 15360, v16
    v_mov_b32 v17, 0
    v_mov_b32 v18, 0xffffff00
    v_mov_b32 v59, s38
    v_mov_b32 v108, 0
    v_and_b32 v110, 16, v7
    s_xor_b32 s42, s38, 0x8000
    v_lshrrev_b32 v110, v110, s42
    v_and_b32 v110, 0xffff, v110
    v_mov_b32 v111, 0xffff0000
    v_lshlrev_b32 v112, 3, v0
    s_and_b32 s39, s36, 24
    s_add_u32 s39, s39, s37
    s_and_b32 s40, s36, 7
    s_lshl_b32 s59, s40, 9
    s_add_u32 s59, s59, 950272
    s_lshr_b32 s44, s36, 3
    s_add_u32 s42, s44, 1
    s_lshr_b32 s57, s42, 1
    s_lshl_b32 s57, s57, 18
    s_and_b32 s42, s42, 1
    s_lshl_b32 s42, s42, 9
    s_add_u32 s57, s57, s42
    s_lshl_b32 s42, s40, 13
    s_add_u32 s57, s57, s42
    s_add_u32 s42, s44, 1
    s_cmp_eq_u32 s42, 4
    s_cselect_b32 s58, 101, 0
    s_min_u32 s42, s42, 3
    s_lshl_b32 s60, 1, s42
    s_or_b32 s60, s60, 16
    s_lshr_b32 s42, s2, 5
    s_and_b32 s43, s2, 7
    s_lshl3_add_u32 s42, s42, s43
    s_bfe_u32 s43, s2, 0x20003
    s_lshl2_add_u32 s47, s42, s43
    s_lshl_b32 s12, s47, 5
    s_add_u32 s12, s12, 786432
    s_min_u32 s42, s42, 39
    s_and_b32 s43, s47, 1
    s_lshl1_add_u32 s42, s42, s43
    s_lshl_b32 s42, s42, 4
    s_bitcmp1_b32 s47, 1
    s_cselect_b32 s43, 1280, 0
    s_add_u32 s13, s42, s43
    s_mov_b32 s46, 0
    s_mov_b32 s41, 1.0
    s_mov_b32 s56, 4
    buffer_load_dwordx2 v[100:101], v15, s[4:7], s13 offen
    s_waitcnt vmcnt(0)
    v_lshlrev_b32 v104, 16, v100
    v_and_b32 v105, 0xffff0000, v100
    v_lshlrev_b32 v106, 16, v101
    v_and_b32 v107, 0xffff0000, v101
    s_bfe_u32 s8, s38, 0x80000
    s_bfe_u32 s9, s38, 0x80008
    s_bfe_u32 s10, s38, 0x80010
    s_bfe_u32 s11, s38, 0x80018
    v_lshrrev_b32 v21, 2, v0
    v_lshlrev_b32 v22, 12, v21
    s_lshl4_add_u32 s42, s39, s59
    v_add_u32 v22, s42, v22
    s_lshl_b32 s42, s36, 5
    s_add_u32 s42, s42, s37
    s_lshl4_add_u32 s42, s42, 966656
    v_mov_b32 v23, s42
    v_cmp_eq_u32 vcc, 4, v21
    s_nop 1
    v_cndmask_b32 v22, v22, v23, vcc
L_wfa:
    ds_read_b32 v19, v5 offset:5524
    s_waitcnt lgkmcnt(0)
    v_readfirstlane_b32 s42, v19
    s_cmp_ge_u32 s42, 4
    s_cbranch_scc1 L_wfa_ok
    s_sleep 8
    s_nop 0
    s_branch L_wfa
L_wfa_ok:
    ds_read_b64 v[54:55], v112 offset:5632
    s_waitcnt lgkmcnt(0)
    v_max_f32_dpp v8, v54, v54 quad_perm:[1,0,3,2] row_mask:0xf bank_mask:0xf
    v_mov_b32 v11, s38
    v_mov_b32 v10, 0
    v_max_f32_dpp v8, v8, v8 quad_perm:[2,3,0,1] row_mask:0xf bank_mask:0xf
    v_sub_f32 v9, v54, v8
    v_mul_f32 v9, 0x3fb8aa3b, v9
    v_exp_f32 v9, v9
    s_nop 0
    v_mul_f32 v9, v9, v55
    s_nop 1
    v_add_f32_dpp v9, v9, v9 quad_perm:[1,0,3,2] row_mask:0xf bank_mask:0xf
    s_nop 1
    v_add_f32_dpp v9, v9, v9 quad_perm:[2,3,0,1] row_mask:0xf bank_mask:0xf
    s_mov_b64 exec, 0x11111
    s_cmp_eq_u32 s30, 0
    s_cbranch_scc0 L_mlfar
    buffer_store_dwordx4 v[8:11], v22, s[24:27], 0 offen
    s_nop 0
    s_branch L_mldone
L_mlfar:
    buffer_store_dwordx4 v[8:11], v22, s[24:27], 0 offen sc1
L_mldone:
    s_mov_b64 exec, -1
L_wp0:
    ds_read_b32 v19, v5 offset:5568
    s_waitcnt lgkmcnt(0)
    v_readfirstlane_b32 s42, v19
    s_cmp_ge_u32 s42, 70
    s_cbranch_scc1 L_wp0_ok
    s_sleep 8
    s_nop 0
    s_branch L_wp0
L_wp0_ok:
L_round:
    s_add_u32 s42, s46, 1
    s_lshr_b32 s61, s42, 1
    s_lshl_b32 s61, s61, 18
    s_and_b32 s42, s42, 1
    s_lshl_b32 s42, s42, 9
    s_add_u32 s61, s61, s42
    s_cmp_eq_u32 s46, 4
    s_cselect_b32 s61, 0, s61
    s_add_u32 s61, s61, s31
    ds_read_b32 v54, v6 offset:5632
L_pollm:
    buffer_load_dwordx4 v[20:23], v12, s[24:27], s59 offen sc1
    s_waitcnt vmcnt(0)
    v_cmp_ne_u32 vcc, s38, v23
    s_nop 3
    s_cbranch_vccz L_pollm_ok
    s_sleep 16
    s_sub_u32 s45, s45, 1
    s_cbranch_scc0 L_pollm
    s_branch L_giveup
L_pollm_ok:
    v_mov_b32 v10, v20
    s_nop 1
    v_max_f32_dpp v10, v10, v10 quad_perm:[1,0,3,2] row_mask:0xf bank_mask:0xf
    s_nop 1
    v_max_f32_dpp v10, v10, v10 quad_perm:[2,3,0,1] row_mask:0xf bank_mask:0xf
    s_nop 1
    v_max_f32_dpp v10, v10, v10 row_half_mirror row_mask:0xf bank_mask:0xf
    s_nop 1
    v_max_f32_dpp v10, v10, v10 row_mirror row_mask:0xf bank_mask:0xf
    v_mov_b32 v11, v10
    s_nop 1
    v_permlane16_swap_b32 v11, v10
    v_max_f32 v10, v11, v10
    s_waitcnt lgkmcnt(0)
    v_sub_f32 v8, v20, v10
    v_sub_f32 v9, v54, v10
    v_mul_f32 v8, 0x3fb8aa3b, v8
    v_mul_f32 v9, 0x3fb8aa3b, v9
    v_exp_f32 v8, v8
    v_exp_f32 v9, v9
    v_mul_f32 v11, v8, v21
    s_nop 1
    v_add_f32_dpp v11, v11, v11 quad_perm:[1,0,3,2] row_mask:0xf bank_mask:0xf
    s_nop 1
    v_add_f32_dpp v11, v11, v11 quad_perm:[2,3,0,1] row_mask:0xf bank_mask:0xf
    s_nop 1
    v_add_f32_dpp v11, v11, v11 row_half_mirror row_mask:0xf bank_mask:0xf
    s_nop 1
    v_add_f32_dpp v11, v11, v11 row_mirror row_mask:0xf bank_mask:0xf
    v_mov_b32 v10, v11
    s_nop 1
    v_permlane16_swap_b32 v10, v11
    v_add_f32 v11, v10, v11
    v_rcp_f32 v11, v11
    v_mul_f32 v9, s41, v9
    v_mul_f32 v124, v9, v11
    v_mov_b32 v52, 0
    v_mov_b32 v53, 0
    v_mov_b32 v54, 0
    s_add_u32 s43, s57, 4096
L_wflag:
    ds_read_b32 v19, v17 offset:5504
    s_waitcnt lgkmcnt(0)
    v_readfirstlane_b32 s42, v19
    s_cmp_ge_u32 s42, 3
    s_cbranch_scc1 L_wflag_ok
    s_sleep 1
    s_nop 0
    s_branch L_wflag
L_wflag_ok:
L_wspec:
    ds_read_b32 v8, v17 offset:5504
    ds_read2st64_b32 v[20:21], v16 offset0:0 offset1:1
    ds_read2st64_b32 v[22:23], v16 offset0:2 offset1:3
    ds_read2st64_b32 v[24:25], v16 offset0:4 offset1:5
    ds_read2st64_b32 v[26:27], v16 offset0:6 offset1:7
    ds_read2st64_b32 v[28:29], v16 offset0:8 offset1:9
    ds_read2st64_b32 v[30:31], v16 offset0:10 offset1:11
    ds_read2st64_b32 v[32:33], v16 offset0:12 offset1:13
    ds_read2st64_b32 v[34:35], v16 offset0:14 offset1:15
    ds_read2st64_b32 v[36:37], v16 offset0:16 offset1:17
    ds_read2st64_b32 v[38:39], v16 offset0:18 offset1:19
    ds_read2st64_b32 v[40:41], v16 offset0:20 offset1:21
    ds_read2st64_b32 v[42:43], v16 offset0:22 offset1:23
    s_waitcnt lgkmcnt(12)
    v_readfirstlane_b32 s42, v8
    s_cmp_lt_u32 s42, 4
    s_cbranch_scc1 L_wspec
    s_waitcnt lgkmcnt(9)
    v_add_f32 v20, v20, v23
    v_add_f32 v21, v21, v24
    v_add_f32 v22, v22, v25
    v_mul_f32_dpp v56, v124, v20 quad_perm:[0,0,0,0] row_mask:0xf bank_mask:0xf
    v_mul_f32_dpp v57, v124, v21 quad_perm:[0,0,0,0] row_mask:0xf bank_mask:0xf
    v_mul_f32_dpp v58, v124, v22 quad_perm:[0,0,0,0] row_mask:0xf bank_mask:0xf
    s_waitcnt lgkmcnt(6)
    v_add_f32 v26, v26, v29
    v_add_f32 v27, v27, v30
    v_add_f32 v28, v28, v31
    v_fmac_f32_dpp v56, v124, v26 quad_perm:[1,1,1,1] row_mask:0xf bank_mask:0xf
    v_fmac_f32_dpp v57, v124, v27 quad_perm:[1,1,1,1] row_mask:0xf bank_mask:0xf
    v_fmac_f32_dpp v58, v124, v28 quad_perm:[1,1,1,1] row_mask:0xf bank_mask:0xf
    s_waitcnt lgkmcnt(3)
    v_add_f32 v32, v32, v35
    v_add_f32 v33, v33, v36
    v_add_f32 v34, v34, v37
    v_fmac_f32_dpp v56, v124, v32 quad_perm:[2,2,2,2] row_mask:0xf bank_mask:0xf
    v_fmac_f32_dpp v57, v124, v33 quad_perm:[2,2,2,2] row_mask:0xf bank_mask:0xf
    v_fmac_f32_dpp v58, v124, v34 quad_perm:[2,2,2,2] row_mask:0xf bank_mask:0xf
    s_waitcnt lgkmcnt(0)
    v_add_f32 v38, v38, v41
    v_add_f32 v39, v39, v42
    v_add_f32 v40, v40, v43
    v_fmac_f32_dpp v56, v124, v38 quad_perm:[3,3,3,3] row_mask:0xf bank_mask:0xf
    v_fmac_f32_dpp v57, v124, v39 quad_perm:[3,3,3,3] row_mask:0xf bank_mask:0xf
    v_fmac_f32_dpp v58, v124, v40 quad_perm:[3,3,3,3] row_mask:0xf bank_mask:0xf
    v_cvt_pk_bf16_f32 v56, v56, v57
    v_cvt_pk_bf16_f32 v57, v58, v58
    s_cmp_eq_u32 s30, 0
    v_and_or_b32 v57, v57, v111, v110
    s_cbranch_scc0 L_pubfar
    buffer_store_dwordx2 v[56:57], v112, s[24:27], s61 offen
L_pubdone:
    s_cmp_eq_u32 s46, 4
    s_cbranch_scc1 L_poll1
    s_bitcmp1_b32 s60, s46
    s_cbranch_scc0 L_next
L_wp1:
    ds_read_b32 v19, v5 offset:5568
    s_waitcnt lgkmcnt(0)
    v_readfirstlane_b32 s42, v19
    s_cmp_ge_u32 s42, s58
    s_cbranch_scc1 L_wp1_ok
    s_sleep 8
    s_nop 0
    s_branch L_wp1
L_wp1_ok:
L_poll1:
    buffer_load_dwordx2 v[128:129], v112, s[24:27], s57 offen offset:0 sc1
    buffer_load_dwordx2 v[132:133], v112, s[24:27], s57 offen offset:1024 sc1
    buffer_load_dwordx2 v[136:137], v112, s[24:27], s57 offen offset:2048 sc1
    buffer_load_dwordx2 v[140:141], v112, s[24:27], s57 offen offset:3072 sc1
    buffer_load_dwordx2 v[144:145], v112, s[24:27], s43 offen offset:0 sc1
    buffer_load_dwordx2 v[148:149], v112, s[24:27], s43 offen offset:1024 sc1
    buffer_load_dwordx2 v[152:153], v112, s[24:27], s43 offen offset:2048 sc1
    buffer_load_dwordx2 v[156:157], v112, s[24:27], s43 offen offset:3072 sc1
    s_waitcnt vmcnt(7)
    v_xor_b32 v129, v110, v129
    v_lshlrev_b32 v130, 16, v128
    v_and_b32 v131, 0xffff0000, v128
    v_add_f32 v22, v129, v54
    v_pk_add_f32 v[20:21], v[130:131], v[52:53]
    s_waitcnt vmcnt(6)
    v_xor_b32 v133, v110, v133
    v_lshlrev_b32 v134, 16, v132
    v_and_b32 v135, 0xffff0000, v132
    v_add_f32 v22, v22, v133
    v_pk_add_f32 v[20:21], v[20:21], v[134:135]
    v_or_b32 v19, v129, v133
    s_waitcnt vmcnt(5)
    v_xor_b32 v137, v110, v137
    v_lshlrev_b32 v138, 16, v136
    v_and_b32 v139, 0xffff0000, v136
    v_add_f32 v22, v22, v137
    v_pk_add_f32 v[20:21], v[20:21], v[138:139]
    s_waitcnt vmcnt(4)
    v_xor_b32 v141, v110, v141
    v_lshlrev_b32 v142, 16, v140
    v_and_b32 v143, 0xffff0000, v140
    v_add_f32 v22, v22, v141
    v_pk_add_f32 v[20:21], v[20:21], v[142:143]
    v_or3_b32 v19, v137, v141, v19
    s_waitcnt vmcnt(3)
    v_xor_b32 v145, v110, v145
    v_lshlrev_b32 v146, 16, v144
    v_and_b32 v147, 0xffff0000, v144
    v_add_f32 v22, v22, v145
    v_pk_add_f32 v[20:21], v[20:21], v[146:147]
    s_waitcnt vmcnt(2)
    v_xor_b32 v149, v110, v149
    v_lshlrev_b32 v150, 16, v148
    v_and_b32 v151, 0xffff0000, v148
    v_add_f32 v22, v22, v149
    v_pk_add_f32 v[20:21], v[20:21], v[150:151]
    v_or3_b32 v19, v145, v149, v19
    s_waitcnt vmcnt(1)
    v_xor_b32 v153, v110, v153
    v_lshlrev_b32 v154, 16, v152
    v_and_b32 v155, 0xffff0000, v152
    v_add_f32 v22, v22, v153
    v_pk_add_f32 v[20:21], v[20:21], v[154:155]
    s_waitcnt vmcnt(0)
    v_xor_b32 v157, v110, v157
    v_lshlrev_b32 v158, 16, v156
    v_and_b32 v159, 0xffff0000, v156
    v_add_f32 v22, v22, v157
    v_pk_add_f32 v[20:21], v[20:21], v[158:159]
    v_or3_b32 v19, v153, v157, v19
    v_cmp_ne_u16 vcc, 0, v19
    s_cmp_eq_u32 s56, 1
    s_cbranch_vccnz L_poll1_no
    s_cbranch_scc1 L_poll1_ok
    v_mov_b32 v52, v20
    v_mov_b32 v53, v21
    v_mov_b32 v54, v22
    s_sub_u32 s56, s56, 1
    s_add_u32 s57, s57, 0x10000
    s_add_u32 s43, s57, 4096
    s_branch L_poll1
L_poll1_no:
    s_sub_u32 s45, s45, 1
    s_cbranch_scc0 L_poll1
    s_branch L_giveup
L_pubfar:
    buffer_store_dwordx2 v[56:57], v112, s[24:27], s61 offen sc1
    s_branch L_pubdone
L_poll1_ok:
    v_cvt_pk_bf16_f32 v20, v20, v21
    v_cvt_pk_bf16_f32 v22, v22, v22
    ds_write_b16 v13, v20 offset:4736
    ds_write_b16_d16_hi v13, v20 offset:4864
    ds_write_b16 v13, v22 offset:4992
    ds_write_b32 v5, v108 offset:5536
    s_cmp_lt_u32 s47, 160
    s_cbranch_scc0 L_nored
    s_cmp_lg_u32 s46, 4
    s_cbranch_scc1 L_poll2
L_wd:
    ds_read_b32 v8, v5 offset:5544
    s_waitcnt lgkmcnt(0)
    v_readfirstlane_b32 s42, v8
    s_cmp_lt_u32 s42, 5
    s_cbranch_scc1 L_wd
L_poll2:
    buffer_load_dwordx4 v[20:23], v14, s[24:27], s12 offen sc1
    s_waitcnt vmcnt(0)
    v_xor_b32 v20, s8, v20
    v_xor_b32 v21, s9, v21
    v_xor_b32 v22, s10, v22
    v_xor_b32 v23, s11, v23
    v_or3_b32 v10, v20, v21, v22
    v_bitop3_b32 v10, v10, v23, v18 bitop3:0x54
    v_cmp_ne_u32 vcc, 0, v10
    s_cmp_lg_u32 s46, 4
    s_cbranch_vccz L_poll2_ok
    s_cbranch_scc1 L_poll2_ok
    s_sub_u32 s45, s45, 1
    s_cbranch_scc0 L_poll2
    s_endpgm
L_poll2_ok:
    v_add_f32_dpp v20, v20, v20 quad_perm:[1,0,3,2] row_mask:0xf bank_mask:0xf
    v_add_f32_dpp v21, v21, v21 quad_perm:[1,0,3,2] row_mask:0xf bank_mask:0xf
    v_add_f32_dpp v22, v22, v22 quad_perm:[1,0,3,2] row_mask:0xf bank_mask:0xf
    v_add_f32_dpp v23, v23, v23 quad_perm:[1,0,3,2] row_mask:0xf bank_mask:0xf
    v_add_f32_dpp v20, v20, v20 quad_perm:[2,3,0,1] row_mask:0xf bank_mask:0xf
    v_add_f32_dpp v21, v21, v21 quad_perm:[2,3,0,1] row_mask:0xf bank_mask:0xf
    v_add_f32_dpp v22, v22, v22 quad_perm:[2,3,0,1] row_mask:0xf bank_mask:0xf
    v_add_f32_dpp v23, v23, v23 quad_perm:[2,3,0,1] row_mask:0xf bank_mask:0xf
    v_add_f32_dpp v20, v20, v20 row_half_mirror row_mask:0xf bank_mask:0xf
    v_add_f32_dpp v21, v21, v21 row_half_mirror row_mask:0xf bank_mask:0xf
    v_add_f32_dpp v22, v22, v22 row_half_mirror row_mask:0xf bank_mask:0xf
    v_add_f32_dpp v23, v23, v23 row_half_mirror row_mask:0xf bank_mask:0xf
    v_add_f32_dpp v20, v20, v20 row_mirror row_mask:0xf bank_mask:0xf
    v_add_f32_dpp v21, v21, v21 row_mirror row_mask:0xf bank_mask:0xf
    v_add_f32_dpp v22, v22, v22 row_mirror row_mask:0xf bank_mask:0xf
    v_add_f32_dpp v23, v23, v23 row_mirror row_mask:0xf bank_mask:0xf
    v_mov_b32 v28, v20
    v_mov_b32 v29, v21
    v_mov_b32 v30, v22
    v_mov_b32 v31, v23
    v_permlane16_swap_b32 v28, v20
    v_permlane16_swap_b32 v29, v21
    v_permlane16_swap_b32 v30, v22
    v_permlane16_swap_b32 v31, v23
    v_add_f32 v20, v28, v20
    v_add_f32 v21, v29, v21
    v_add_f32 v22, v30, v22
    v_add_f32 v23, v31, v23
    v_add_f32 v20, v104, v20
    v_add_f32 v21, v105, v21
    v_add_f32 v22, v106, v22
    v_add_f32 v23, v107, v23
    v_cvt_pk_bf16_f32 v20, v20, v21
    v_cvt_pk_bf16_f32 v21, v22, v23
    s_cbranch_scc1 L_next
    s_mov_b32 exec_lo, 1
    s_mov_b32 exec_hi, 1
    buffer_store_dwordx2 v[20:21], v15, s[32:35], s13 offen
    s_cmp_lg_u32 s47, 0
    s_cbranch_scc1 L_hdone
    s_mov_b32 s42, 983040
    s_mov_b64 exec, 1
    buffer_store_dword v59, v5, s[24:27], s42 offen
L_nored:
    s_cmp_eq_u32 s46, 4
    s_cbranch_scc1 L_hdone
L_next:
    s_add_u32 s46, s46, 1
    s_add_u32 s59, s59, 4096
    v_add_u32 v16, 6144, v16
    v_add_u32 v6, 32, v6
    v_add_u32 v17, 4, v17
    s_cmp_lt_u32 s46, 4
    s_cbranch_scc1 L_round
    s_lshl_b32 s57, s36, 13
    s_lshl_b32 s59, s36, 9
    s_add_u32 s59, s59, 966656
    s_mov_b32 s41, 4.0
    v_subrev_u32 v13, 384, v13
    v_mov_b32 v108, 1
    v_and_b32 v14, 0xffffff, v14
    v_mov_b32 v12, v125
    s_nop 0
    s_branch L_round
L_hdone:
L_end:
    s_endpgm
.section .rodata,"a"
.p2align 6
.amdhsa_kernel parallel_sum__mha_block_cached__dense_activation_relu__decode_kernel
  .amdhsa_next_free_vgpr 256
  .amdhsa_next_free_sgpr 96
  .amdhsa_accum_offset 256
  .amdhsa_group_segment_fixed_size 0
  .amdhsa_kernarg_size 88
  .amdhsa_user_sgpr_count 2
  .amdhsa_user_sgpr_kernarg_segment_ptr 1
  .amdhsa_system_sgpr_workgroup_id_x 1
  .amdhsa_float_denorm_mode_32 3
.end_amdhsa_kernel
```
